```python
import torch

def _softmax(x, axis=-1):
    return torch.softmax(x, dim=axis)
def _gelu(x):
    return torch.nn.functional.gelu(x, approximate="tanh")
def _silu(x):
    return torch.nn.functional.silu(x)
def _sigmoid(x):
    return torch.sigmoid(x)
def _layernorm(x, axis=-1, eps=1e-5):
    m = x.mean(dim=axis, keepdim=True)
    v = x.var(dim=axis, keepdim=True, unbiased=False)
    return (x - m) / torch.sqrt(v + eps)
def _scatter_add(tgt, idx, src, axis=0):
    return tgt.clone().index_add_(axis, idx, src)
def _segment_sum(src, seg, n):
    out = torch.zeros((n,) + src.shape[1:], dtype=src.dtype)
    return out.index_add_(0, seg, src)
def _pad(x, pw):
    flat = tuple(v for pair in reversed(pw) for v in pair)
    return torch.nn.functional.pad(x, flat)

kernel_name = 'concat_heads__ssm_conv_h3__ssm_conv_s4__prompt'

def setup_inputs():

    _w = (lambda a: (lambda t: t.to(torch.bfloat16) if t.is_floating_point() else t)(torch.as_tensor(a)))
    def _A_setup():
        B, S, D = 1, 2048, 640
        ks = 4
        return {
            "q": _w((lambda *s: torch.randn(*s, dtype=torch.bfloat16) * 0.05)(B, S, D)),
            "k": _w((lambda *s: torch.randn(*s, dtype=torch.bfloat16) * 0.2)(B, S, D)),
            "v": _w((lambda *s: torch.randn(*s, dtype=torch.bfloat16) * 0.2)(B, S, D)),
            "shift_k": _w((lambda *s: torch.randn(*s, dtype=torch.bfloat16) * 0.2)(D, ks) * 0.5),
            "ssm_k": _w((lambda *s: torch.randn(*s, dtype=torch.bfloat16) * 0.8)(D, S) * (1.0 / S ** 0.5)),
            "ssm_D": _w((lambda *s: torch.randn(*s, dtype=torch.bfloat16) * 0.2)(D)),
        }
    _A_in = _A_setup()

    def _B_setup():
        B, L, D, N = 1, 2048, 640, 192
        A_re = -(lambda _x: torch.exp(torch.as_tensor(_x)))((lambda *s: torch.randn(*s, dtype=torch.bfloat16) * 3.2)(D, N))
        A_im = torch.pi * (lambda *s: torch.randn(*s, dtype=torch.bfloat16) * 0.05)(D, N)
        B_re = (lambda *s: torch.randn(*s, dtype=torch.bfloat16) * 0.1)(D, N)
        B_im = (lambda *s: torch.randn(*s, dtype=torch.bfloat16) * 0.1)(D, N)
        C_re = (lambda *s: torch.randn(*s, dtype=torch.bfloat16) * 0.1)(D, N)
        C_im = (lambda *s: torch.randn(*s, dtype=torch.bfloat16) * 0.1)(D, N)
        log_dt = (lambda *s: torch.randn(*s, dtype=torch.bfloat16) * 0.05)(D) * 0.5 - 4.0
        Dskip = (lambda *s: torch.randn(*s, dtype=torch.bfloat16) * 0.05)(D)
        return {
            "u": _w((lambda *s: torch.randn(*s, dtype=torch.bfloat16) * 0.05)(B, L, D)),
            "A_re": _w(A_re),
            "A_im": _w(A_im),
            "B_re": _w(B_re),
            "B_im": _w(B_im),
            "C_re": _w(C_re),
            "C_im": _w(C_im),
            "log_dt": _w(log_dt),
            "Dskip": _w(Dskip),
        }
    _B_in = _B_setup()

    return {
        "A_q": _A_in["q"],
        "A_k": _A_in["k"],
        "A_v": _A_in["v"],
        "A_shift_k": _A_in["shift_k"],
        "A_ssm_k": _A_in["ssm_k"],
        "A_ssm_D": _A_in["ssm_D"],
        "B_u": _B_in["u"],
        "B_A_re": _B_in["A_re"],
        "B_A_im": _B_in["A_im"],
        "B_B_re": _B_in["B_re"],
        "B_B_im": _B_in["B_im"],
        "B_C_re": _B_in["C_re"],
        "B_C_im": _B_in["C_im"],
        "B_log_dt": _B_in["log_dt"],
        "B_Dskip": _B_in["Dskip"],
    }

def reference(A_q, A_k, A_v, A_shift_k, A_ssm_k, A_ssm_D, B_u, B_A_re, B_A_im, B_B_re, B_B_im, B_C_re, B_C_im, B_log_dt, B_Dskip):
    def _A_ref(q, k, v, shift_k, ssm_k, ssm_D):
        B, S, D = q.shape
        ks = shift_k.shape[-1]
        k_pad = _pad(k, ((0, 0), (ks - 1, 0), (0, 0)))
        k_shift = torch.zeros_like(k)
        for t in range(ks):
            k_shift = k_shift + k_pad[:, t:t + S, :] * shift_k[:, ks - 1 - t][None, None, :]
        kv = k_shift * v
        L = 2 * S
        kv_pad = _pad(kv, ((0, 0), (0, S), (0, 0)))
        kf_pad = _pad(ssm_k, ((0, 0), (0, S)))
        kv_f = (lambda x, axes=(-2,-1): torch.fft.rfft2(x.float(), dim=axes))(kv_pad[:, None, :, :], axes=(1, 2))
        kf_f = (lambda x, axes=(-2,-1): torch.fft.rfft2(x.float(), dim=axes))(kf_pad[:, None, :], axes=(1, 2))
        kf_f = (lambda x, *d: x.permute(*d))(kf_f, 1, 2, 0)
        y_f = kv_f * kf_f[None, :, :, :]
        y = (lambda x, s, axes=(-2,-1): torch.fft.irfft2(x, s=s, dim=axes).to(torch.bfloat16))(y_f, (1, L), axes=(1, 2))[:, 0, :S, :]
        y = y + kv * ssm_D[None, None, :]
        return q * y

    def _B_ref(u, A_re, A_im, B_re, B_im, C_re, C_im, log_dt, Dskip):
        Bsz, L, D = u.shape
        dt = torch.exp(log_dt)[:, None]
        A = A_re + 1j * A_im
        Bc = B_re + 1j * B_im
        Cc = C_re + 1j * C_im
        logdA = dt * A
        dB = dt * Bc
        l = (lambda x, dt: x.to(dt))(torch.arange(L), A_re.dtype)
        P = torch.exp(logdA[:, :, None] * l[None, None, :])
        K = torch.einsum("dn,dnl,dn->dl", Cc, P, dB).real
        L2 = 2 * L
        Kp = _pad(K, ((0, 0), (0, L)))
        up = (lambda x, *d: x.permute(*d))(u, 0, 2, 1)
        up = _pad(up, ((0, 0), (0, 0), (0, L)))
        Kf = (lambda x, axes=(-2,-1): torch.fft.rfft2(x.float(), dim=axes))(Kp[:, None, :], axes=(-2, -1))
        Uf = (lambda x, axes=(-2,-1): torch.fft.rfft2(x.float(), dim=axes))(up[:, :, None, :], axes=(-2, -1))
        Yf = Uf * Kf[None, :, :, :]
        y = (lambda x, s, axes=(-2,-1): torch.fft.irfft2(x, s=s, dim=axes).to(torch.bfloat16))(Yf, (1, L2), axes=(-2, -1))[:, :, 0, :L]
        y = (lambda x, *d: x.permute(*d))(y, 0, 2, 1) + u * Dskip[None, None, :]
        return y

    a = _A_ref(A_q, A_k, A_v, A_shift_k, A_ssm_k, A_ssm_D)
    b = _B_ref(B_u, B_A_re, B_A_im, B_B_re, B_B_im, B_C_re, B_C_im, B_log_dt, B_Dskip)
    return torch.concatenate([a, b], axis=-1)
```

```asm
; @launch grid=(256,1,1) block=(768,1,1) lds=163328
.amdgcn_target "amdgcn-amd-amdhsa--gfx950"
.text
.globl concat_heads__ssm_conv_h3__ssm_conv_s4__prompt_kernel
.p2align 8
.type concat_heads__ssm_conv_h3__ssm_conv_s4__prompt_kernel,@function
concat_heads__ssm_conv_h3__ssm_conv_s4__prompt_kernel:
    s_load_dwordx16 s[8:23], s[0:1], 0
    s_load_dwordx16 s[24:39], s[0:1], 64
    s_getpc_b64 s[98:99]
L_pc:
    v_lshrrev_b32 v2, 6, v0
    v_and_b32 v1, 63, v0
    s_and_b32 s4, s2, 7
    v_readfirstlane_b32 s5, v2
    s_lshr_b32 s7, s2, 3
    s_cmp_ge_u32 s5, 3
    s_cselect_b32 s6, 1, 0
    s_lshr_b32 s47, s7, 1
    s_or_b32 s6, s6, s47
    s_cbranch_scc1 L_nocpf
    v_lshlrev_b32 v10, 7, v0
    v_min_u32 v10, L_end-L_pc, v10
    global_load_dword v100, v10, s[98:99]
L_nocpf:
    s_cmp_lt_u32 s4, 4
    s_cselect_b32 s6, 28, 32
    s_cselect_b32 s47, 12, 8
    s_cmp_ge_u32 s7, s6
    s_cbranch_scc1 L_end
    v_lshlrev_b32 v2, 2, v1
    v_and_b32 v2, 63, v2
    v_mov_b32 v3, 0
    ds_write_b32 v2, v3
    ds_write_b32 v2, v3 offset:20416
    s_cmp_ge_u32 s7, s47
    s_cbranch_scc1 L_wgB
    s_lshl_b32 s3, s4, 3
    s_lshl_b32 s46, s4, 2
    s_add_u32 s46, s46, 56
    s_cmp_ge_u32 s7, 8
    s_cselect_b32 s3, s46, s3
    s_add_u32 s3, s3, s7
    s_lshl_b32 s45, s3, 4
    s_cmp_lt_u32 s5, 8
    s_cbranch_scc1 L_mwaveA
    s_setprio 3
    s_sub_u32 s44, s5, 8
    s_mov_b32 s46, s44
    v_subrev_u32 v2, 512, v0
    v_mul_u32_u24 v3, 2560, v2
    v_add_u32 v3, s45, v3
    v_mov_b32 v16, 0
    v_mov_b32 v17, 0
    v_mov_b32 v18, 0
    v_mov_b32 v19, 0
    v_mov_b32 v20, 0
    v_mov_b32 v21, 0
    v_mov_b32 v22, 0
    v_mov_b32 v23, 0
    v_mov_b32 v24, 0
    v_mov_b32 v25, 0
    v_mov_b32 v26, 0
    v_mov_b32 v27, 0
    s_lshl_b32 s6, s3, 6
    s_waitcnt lgkmcnt(0)
    s_load_dwordx16 s[48:63], s[14:15], s6
    s_barrier
    s_cmp_eq_u32 s44, 0
    s_cbranch_scc1 L_nohalo5
    s_mov_b64 exec, 1
    global_load_dwordx4 v[16:19], v3, s[10:11] offset:-3840
    global_load_dwordx4 v[20:23], v3, s[10:11] offset:-2560
    global_load_dwordx4 v[24:27], v3, s[10:11] offset:-1280
    s_mov_b64 exec, -1
L_nohalo5:
    global_load_dwordx4 v[28:31], v3, s[10:11] offset:0
    global_load_dwordx4 v[36:39], v3, s[12:13] offset:0
    global_load_dwordx4 v[32:35], v3, s[10:11] offset:1280
    global_load_dwordx4 v[40:43], v3, s[12:13] offset:1280
    v_add_u32 v3, 655360, v3
    s_branch L_helperA2
L_wgB:
    s_sub_u32 s50, s7, s47
    s_lshl_b32 s3, s4, 4
    s_lshl_b32 s46, s4, 3
    s_add_u32 s46, s46, 80
    s_cmp_ge_u32 s50, 16
    s_cselect_b32 s3, s46, s3
    s_add_u32 s3, s3, s50
    s_lshl_b32 s45, s3, 3
    s_and_b32 s6, s5, 3
    s_mul_i32 s44, s6, 20416
    s_lshl_b32 s46, s3, 2
    s_add_u32 s46, s46, s6
    v_mov_b32 v16, 0
    v_mov_b32 v17, 0
    v_mov_b32 v18, 0
    v_mov_b32 v19, 0
    v_mov_b32 v20, 0
    v_mov_b32 v21, 0
    v_mov_b32 v22, 0
    v_mov_b32 v23, 0
    s_mul_i32 s6, s46, 384
    s_lshr_b32 s7, s5, 2
    s_lshl_b32 s7, s7, 7
    s_add_u32 s6, s6, s7
    v_lshlrev_b32 v9, 1, v1
    v_add_u32 v9, s6, v9
    s_lshl_b32 s7, s46, 1
    v_mov_b32 v10, s7
    s_mov_b32 s57, 100000
    s_lshl_b32 s51, s4, 7
    s_bfe_u32 s52, s4, 0x10001
    s_add_u32 s52, s52, 8
    s_lshl_b32 s52, s52, 7
    s_and_b32 s6, s50, 7
    s_lshl_b32 s6, s6, 6
    v_add_u32 v24, s6, v1
    v_mul_u32_u24 v24, 1280, v24
    s_waitcnt lgkmcnt(0)
    global_load_short_d16_hi v22, v10, s[34:35]
    global_load_short_d16_hi v16, v9, s[22:23]
    global_load_short_d16_hi v17, v9, s[24:25]
    global_load_short_d16_hi v18, v9, s[26:27]
    global_load_short_d16_hi v19, v9, s[28:29]
    global_load_short_d16_hi v20, v9, s[30:31]
    global_load_short_d16_hi v21, v9, s[32:33]
    global_load_short_d16_hi v23, v10, s[36:37]
    s_branch L_wgB2
L_mwaveA:
    s_mul_i32 s44, s5, 20416
    s_lshl_b32 s46, s3, 3
    s_add_u32 s46, s46, s5
    s_lshl_b32 s6, s46, 12
    v_lshlrev_b32 v9, 4, v1
    v_add_u32 v9, s6, v9
    s_waitcnt lgkmcnt(0)
    global_load_dwordx4 v[60:63], v9, s[16:17] offset:0
    global_load_dwordx4 v[64:67], v9, s[16:17] offset:1024
    global_load_dwordx4 v[68:71], v9, s[16:17] offset:2048
    global_load_dwordx4 v[72:75], v9, s[16:17] offset:3072
    s_barrier
    s_lshr_b32 s7, s46, 1
    s_lshl_b32 s7, s7, 2
    s_load_dword s48, s[18:19], s7
    s_mov_b32 s58, 1
    v_lshlrev_b32 v3, 4, v1
    v_add_u32 v3, s44, v3
    v_add_u32 v3, 56, v3
    v_mov_b32 v84, 0
    v_mov_b32 v85, 0
    v_lshlrev_b32 v86, 3, v1
    v_add_u32 v86, s44, v86
    v_mov_b32 v87, s44
    ds_write_b64 v86, v[84:85] offset:4160
    ds_write_b64 v86, v[84:85] offset:8800
    ds_write_b64 v86, v[84:85] offset:13480
    ds_write_b32 v87, v84 offset:4156
    v_mov_b32 v76, 0
    s_waitcnt lgkmcnt(0)
    s_lshl_b32 s6, s48, 16
    s_and_b32 s7, s48, 0xffff0000
    s_bitcmp1_b32 s46, 0
    s_cselect_b32 s6, s7, s6
    s_waitcnt vmcnt(3)
    s_mov_b64 exec, 1
    v_lshlrev_b32 v84, 16, v60
    v_add_f32 v84, s6, v84
    v_and_b32 v85, 0xffff0000, v60
    v_cvt_pk_bf16_f32 v60, v84, v85
    s_mov_b64 exec, -1
    v_mov_b32_dpp v76, v63 wave_shr:1 row_mask:0xf bank_mask:0xf
    v_alignbit_b32 v84, v60, v76, 16
    v_alignbit_b32 v85, v61, v60, 16
    v_alignbit_b32 v86, v62, v61, 16
    v_alignbit_b32 v87, v63, v62, 16
    ds_write_b128 v3, v[60:63] offset:13480
    ds_write_b128 v3, v[84:87] offset:9256
    s_waitcnt vmcnt(2)
    v_mov_b32_dpp v77, v63 wave_ror:1 row_mask:0xf bank_mask:0xf
    s_nop 1
    v_mov_b32_dpp v77, v67 wave_shr:1 row_mask:0xf bank_mask:0xf
    v_alignbit_b32 v88, v64, v77, 16
    v_alignbit_b32 v89, v65, v64, 16
    v_alignbit_b32 v90, v66, v65, 16
    v_alignbit_b32 v91, v67, v66, 16
    ds_write_b128 v3, v[64:67] offset:14504
    ds_write_b128 v3, v[88:91] offset:10280
    s_waitcnt vmcnt(1)
    v_mov_b32_dpp v78, v67 wave_ror:1 row_mask:0xf bank_mask:0xf
    s_nop 1
    v_mov_b32_dpp v78, v71 wave_shr:1 row_mask:0xf bank_mask:0xf
    v_alignbit_b32 v84, v68, v78, 16
    v_alignbit_b32 v85, v69, v68, 16
    v_alignbit_b32 v86, v70, v69, 16
    v_alignbit_b32 v87, v71, v70, 16
    ds_write_b128 v3, v[68:71] offset:15528
    ds_write_b128 v3, v[84:87] offset:11304
    s_waitcnt vmcnt(0)
    v_mov_b32_dpp v79, v71 wave_ror:1 row_mask:0xf bank_mask:0xf
    s_nop 1
    v_mov_b32_dpp v79, v75 wave_shr:1 row_mask:0xf bank_mask:0xf
    v_alignbit_b32 v88, v72, v79, 16
    v_alignbit_b32 v89, v73, v72, 16
    v_alignbit_b32 v90, v74, v73, 16
    v_alignbit_b32 v91, v75, v74, 16
    ds_write_b128 v3, v[72:75] offset:16552
    ds_write_b128 v3, v[88:91] offset:12328
L_conv:
    v_and_b32 v6, 1, v1
    v_mul_u32_u24 v2, 4224, v6
    v_mul_u32_u24 v4, 4640, v6
    v_and_b32 v5, 31, v1
    v_lshlrev_b32 v5, 2, v5
    v_lshrrev_b32 v7, 5, v1
    v_lshl_add_u32 v5, v7, 8, v5
    v_bfe_u32 v6, v1, 1, 3
    v_lshl_add_u32 v2, v6, 3, v2
    v_lshrrev_b32 v7, 4, v1
    v_lshl_add_u32 v2, v7, 4, v2
    v_lshl_add_u32 v4, v7, 4, v4
    s_and_b32 s6, s5, 3
    s_lshl_b32 s6, s6, 4
    s_add_u32 s6, s6, s44
    v_add_u32 v5, s6, v5
    s_add_u32 s6, s44, 9256
    v_add_u32 v2, s6, v2
    s_add_u32 s6, s44, 512
    v_add_u32 v4, s6, v4
    v_lshlrev_b32 v6, 6, v6
    v_sub_u32 v4, v4, v6
    v_mov_b32 v3, 0
    s_mov_b32 s57, 100000
    v_mov_b32 v10, 1
    v_mov_b32 v11, 1
    ds_read_b64 v[44:45], v2 offset:0
    ds_read_b64 v[46:47], v2 offset:8
    ds_read_b64 v[48:49], v2 offset:512
    ds_read_b64 v[50:51], v2 offset:520
    ds_read_b64 v[52:53], v2 offset:64
    ds_read_b64 v[54:55], v2 offset:72
    ds_read_b64 v[56:57], v2 offset:576
    ds_read_b64 v[58:59], v2 offset:584
    ds_read_b64 v[60:61], v2 offset:128
    ds_read_b64 v[62:63], v2 offset:136
    ds_read_b64 v[64:65], v2 offset:640
    ds_read_b64 v[66:67], v2 offset:648
    ds_read_b64 v[68:69], v2 offset:192
    ds_read_b64 v[70:71], v2 offset:200
    ds_read_b64 v[72:73], v2 offset:704
    ds_read_b64 v[74:75], v2 offset:712
    ds_read_b64 v[76:77], v2 offset:256
    ds_read_b64 v[78:79], v2 offset:264
    ds_read_b64 v[80:81], v2 offset:768
    ds_read_b64 v[82:83], v2 offset:776
    ds_read_b64 v[84:85], v2 offset:320
    ds_read_b64 v[86:87], v2 offset:328
    ds_read_b64 v[88:89], v2 offset:832
    ds_read_b64 v[90:91], v2 offset:840
    ds_read_b64 v[92:93], v2 offset:384
    ds_read_b64 v[94:95], v2 offset:392
    ds_read_b64 v[96:97], v2 offset:896
    ds_read_b64 v[98:99], v2 offset:904
    ds_read_b64 v[100:101], v2 offset:448
    ds_read_b64 v[102:103], v2 offset:456
    ds_read_b64 v[104:105], v2 offset:960
    ds_read_b64 v[106:107], v2 offset:968
    ds_read_b64 v[108:109], v2 offset:1024
    ds_read_b64 v[110:111], v2 offset:1032
    ds_read_b64 v[112:113], v2 offset:1536
    ds_read_b64 v[114:115], v2 offset:1544
    ds_read_b64 v[116:117], v2 offset:2048
    ds_read_b64 v[118:119], v2 offset:2056
    ds_read_b64 v[120:121], v2 offset:2560
    ds_read_b64 v[122:123], v2 offset:2568
    ds_read_b64 v[124:125], v2 offset:3072
    ds_read_b64 v[126:127], v2 offset:3080
    ds_read_b64 v[128:129], v2 offset:3584
    ds_read_b64 v[130:131], v2 offset:3592
    ds_read_b64 v[132:133], v2 offset:1088
    ds_read_b64 v[134:135], v2 offset:1096
    ds_read_b64 v[136:137], v2 offset:1600
    ds_read_b64 v[138:139], v2 offset:1608
    ds_read_b64 v[140:141], v2 offset:2112
    ds_read_b64 v[142:143], v2 offset:2120
    ds_read_b64 v[144:145], v2 offset:2624
    ds_read_b64 v[146:147], v2 offset:2632
    ds_read_b64 v[148:149], v2 offset:3136
    ds_read_b64 v[150:151], v2 offset:3144
L_spin1:
    ds_read_b32 v1, v3 offset:0
    s_waitcnt lgkmcnt(0)
    v_readfirstlane_b32 s7, v1
    s_nop 0
    s_cmp_ge_u32 s7, 4
    s_cbranch_scc1 L_spun1
    s_sub_u32 s57, s57, 1
    s_cbranch_scc0 L_spin1
    s_mov_b32 s57, 0
L_spun1:
    ds_read_b128 v[152:155], v4 offset:3072
    ds_read_b128 v[156:159], v4 offset:3584
    s_setprio 2
    s_waitcnt lgkmcnt(1)
    v_mfma_f32_16x16x32_bf16 v[16:19], v[44:47], v[152:155], 0
    ds_read_b128 v[160:163], v4 offset:3136
    s_waitcnt lgkmcnt(1)
    v_mfma_f32_16x16x32_bf16 v[12:15], v[44:47], v[156:159], 0
    ds_read_b128 v[164:167], v4 offset:3648
    v_mfma_f32_16x16x32_bf16 v[20:23], v[48:51], v[152:155], 0
    v_mfma_f32_16x16x32_bf16 v[16:19], v[48:51], v[156:159], v[16:19]
    v_mfma_f32_16x16x32_bf16 v[24:27], v[108:111], v[152:155], 0
    v_mfma_f32_16x16x32_bf16 v[20:23], v[108:111], v[156:159], v[20:23]
    ds_read_b64 v[108:109], v2 offset:3648
    v_mfma_f32_16x16x32_bf16 v[28:31], v[112:115], v[152:155], 0
    ds_read_b64 v[110:111], v2 offset:3656
    v_mfma_f32_16x16x32_bf16 v[24:27], v[112:115], v[156:159], v[24:27]
    ds_read_b128 v[112:115], v4 offset:3200
    v_mfma_f32_16x16x32_bf16 v[32:35], v[116:119], v[152:155], 0
    v_mfma_f32_16x16x32_bf16 v[28:31], v[116:119], v[156:159], v[28:31]
    ds_read_b128 v[116:119], v4 offset:3712
    v_mfma_f32_16x16x32_bf16 v[36:39], v[120:123], v[152:155], 0
    v_mfma_f32_16x16x32_bf16 v[32:35], v[120:123], v[156:159], v[32:35]
    ds_read_b64 v[120:121], v2 offset:1152
    v_mfma_f32_16x16x32_bf16 v[40:43], v[124:127], v[152:155], 0
    ds_read_b64 v[122:123], v2 offset:1160
    v_mfma_f32_16x16x32_bf16 v[36:39], v[124:127], v[156:159], v[36:39]
    ds_read_b64 v[152:153], v2 offset:1664
    v_mfma_f32_16x16x32_bf16 v[40:43], v[128:131], v[156:159], v[40:43]
    ds_read_b64 v[154:155], v2 offset:1672
    s_waitcnt lgkmcnt(9)
    v_mfma_f32_16x16x32_bf16 v[16:19], v[52:55], v[160:163], v[16:19]
    ds_read_b64 v[124:125], v2 offset:2176
    s_waitcnt lgkmcnt(9)
    v_mfma_f32_16x16x32_bf16 v[12:15], v[52:55], v[164:167], v[12:15]
    ds_read_b64 v[126:127], v2 offset:2184
    v_mfma_f32_16x16x32_bf16 v[20:23], v[56:59], v[160:163], v[20:23]
    ds_read_b64 v[128:129], v2 offset:2688
    v_mfma_f32_16x16x32_bf16 v[16:19], v[56:59], v[164:167], v[16:19]
    ds_read_b64 v[130:131], v2 offset:2696
    v_mfma_f32_16x16x32_bf16 v[24:27], v[132:135], v[160:163], v[24:27]
    ds_read_b64 v[156:157], v2 offset:3200
    v_mfma_f32_16x16x32_bf16 v[20:23], v[132:135], v[164:167], v[20:23]
    ds_read_b64 v[158:159], v2 offset:3208
    v_mfma_f32_16x16x32_bf16 v[28:31], v[136:139], v[160:163], v[28:31]
    ds_read_b64 v[132:133], v2 offset:3712
    v_mfma_f32_16x16x32_bf16 v[24:27], v[136:139], v[164:167], v[24:27]
    v_mfma_f32_16x16x32_bf16 v[32:35], v[140:143], v[160:163], v[32:35]
    v_mfma_f32_16x16x32_bf16 v[28:31], v[140:143], v[164:167], v[28:31]
    v_mfma_f32_16x16x32_bf16 v[36:39], v[144:147], v[160:163], v[36:39]
    v_mfma_f32_16x16x32_bf16 v[32:35], v[144:147], v[164:167], v[32:35]
    v_mfma_f32_16x16x32_bf16 v[40:43], v[148:151], v[160:163], v[40:43]
    v_mfma_f32_16x16x32_bf16 v[36:39], v[148:151], v[164:167], v[36:39]
    s_waitcnt lgkmcnt(13)
    v_mfma_f32_16x16x32_bf16 v[40:43], v[108:111], v[164:167], v[40:43]
    ds_read_b64 v[134:135], v2 offset:3720
    s_waitcnt lgkmcnt(13)
    v_mfma_f32_16x16x32_bf16 v[16:19], v[60:63], v[112:115], v[16:19]
    ds_read_b128 v[136:139], v4 offset:3264
    s_waitcnt lgkmcnt(13)
    v_mfma_f32_16x16x32_bf16 v[12:15], v[60:63], v[116:119], v[12:15]
    ds_read_b128 v[140:143], v4 offset:3776
    v_mfma_f32_16x16x32_bf16 v[20:23], v[64:67], v[112:115], v[20:23]
    ds_read_b64 v[144:145], v2 offset:1216
    v_mfma_f32_16x16x32_bf16 v[16:19], v[64:67], v[116:119], v[16:19]
    s_waitcnt lgkmcnt(13)
    v_mfma_f32_16x16x32_bf16 v[24:27], v[120:123], v[112:115], v[24:27]
    ds_read_b64 v[146:147], v2 offset:1224
    v_mfma_f32_16x16x32_bf16 v[20:23], v[120:123], v[116:119], v[20:23]
    ds_read_b64 v[160:161], v2 offset:1728
    s_waitcnt lgkmcnt(13)
    v_mfma_f32_16x16x32_bf16 v[28:31], v[152:155], v[112:115], v[28:31]
    ds_read_b64 v[162:163], v2 offset:1736
    v_mfma_f32_16x16x32_bf16 v[24:27], v[152:155], v[116:119], v[24:27]
    ds_read_b64 v[148:149], v2 offset:2240
    s_waitcnt lgkmcnt(13)
    v_mfma_f32_16x16x32_bf16 v[32:35], v[124:127], v[112:115], v[32:35]
    ds_read_b64 v[150:151], v2 offset:2248
    v_mfma_f32_16x16x32_bf16 v[28:31], v[124:127], v[116:119], v[28:31]
    ds_read_b64 v[108:109], v2 offset:2752
    s_waitcnt lgkmcnt(13)
    v_mfma_f32_16x16x32_bf16 v[36:39], v[128:131], v[112:115], v[36:39]
    ds_read_b64 v[110:111], v2 offset:2760
    v_mfma_f32_16x16x32_bf16 v[32:35], v[128:131], v[116:119], v[32:35]
    ds_read_b64 v[164:165], v2 offset:3264
    s_waitcnt lgkmcnt(13)
    v_mfma_f32_16x16x32_bf16 v[40:43], v[156:159], v[112:115], v[40:43]
    ds_read_b64 v[166:167], v2 offset:3272
    v_mfma_f32_16x16x32_bf16 v[36:39], v[156:159], v[116:119], v[36:39]
    ds_read_b64 v[120:121], v2 offset:3776
    s_waitcnt lgkmcnt(13)
    v_mfma_f32_16x16x32_bf16 v[40:43], v[132:135], v[116:119], v[40:43]
    ds_read_b64 v[122:123], v2 offset:3784
    s_waitcnt lgkmcnt(13)
    v_mfma_f32_16x16x32_bf16 v[16:19], v[68:71], v[136:139], v[16:19]
    ds_read_b128 v[152:155], v4 offset:3328
    s_waitcnt lgkmcnt(13)
    v_mfma_f32_16x16x32_bf16 v[12:15], v[68:71], v[140:143], v[12:15]
    ds_read_b128 v[124:127], v4 offset:3840
    v_mfma_f32_16x16x32_bf16 v[20:23], v[72:75], v[136:139], v[20:23]
    ds_read_b64 v[128:129], v2 offset:1280
    v_mfma_f32_16x16x32_bf16 v[16:19], v[72:75], v[140:143], v[16:19]
    s_waitcnt lgkmcnt(13)
    v_mfma_f32_16x16x32_bf16 v[24:27], v[144:147], v[136:139], v[24:27]
    ds_read_b64 v[130:131], v2 offset:1288
    v_mfma_f32_16x16x32_bf16 v[20:23], v[144:147], v[140:143], v[20:23]
    ds_read_b64 v[112:113], v2 offset:1792
    s_waitcnt lgkmcnt(13)
    v_mfma_f32_16x16x32_bf16 v[28:31], v[160:163], v[136:139], v[28:31]
    ds_read_b64 v[114:115], v2 offset:1800
    v_mfma_f32_16x16x32_bf16 v[24:27], v[160:163], v[140:143], v[24:27]
    ds_read_b64 v[156:157], v2 offset:2304
    s_waitcnt lgkmcnt(13)
    v_mfma_f32_16x16x32_bf16 v[32:35], v[148:151], v[136:139], v[32:35]
    ds_read_b64 v[158:159], v2 offset:2312
    v_mfma_f32_16x16x32_bf16 v[28:31], v[148:151], v[140:143], v[28:31]
    ds_read_b64 v[132:133], v2 offset:2816
    s_waitcnt lgkmcnt(13)
    v_mfma_f32_16x16x32_bf16 v[36:39], v[108:111], v[136:139], v[36:39]
    ds_read_b64 v[134:135], v2 offset:2824
    v_mfma_f32_16x16x32_bf16 v[32:35], v[108:111], v[140:143], v[32:35]
    ds_read_b64 v[116:117], v2 offset:3328
    s_waitcnt lgkmcnt(13)
    v_mfma_f32_16x16x32_bf16 v[40:43], v[164:167], v[136:139], v[40:43]
    ds_read_b64 v[118:119], v2 offset:3336
    v_mfma_f32_16x16x32_bf16 v[36:39], v[164:167], v[140:143], v[36:39]
    ds_read_b64 v[144:145], v2 offset:3840
    s_waitcnt lgkmcnt(13)
    v_mfma_f32_16x16x32_bf16 v[40:43], v[120:123], v[140:143], v[40:43]
    ds_read_b64 v[146:147], v2 offset:3848
    s_waitcnt lgkmcnt(13)
    v_mfma_f32_16x16x32_bf16 v[16:19], v[76:79], v[152:155], v[16:19]
    ds_read_b128 v[160:163], v4 offset:3392
    s_waitcnt lgkmcnt(13)
    v_mfma_f32_16x16x32_bf16 v[12:15], v[76:79], v[124:127], v[12:15]
    ds_read_b128 v[148:151], v4 offset:3904
    v_mfma_f32_16x16x32_bf16 v[20:23], v[80:83], v[152:155], v[20:23]
    ds_read_b64 v[108:109], v2 offset:1344
    v_mfma_f32_16x16x32_bf16 v[16:19], v[80:83], v[124:127], v[16:19]
    s_waitcnt lgkmcnt(13)
    v_mfma_f32_16x16x32_bf16 v[24:27], v[128:131], v[152:155], v[24:27]
    ds_read_b64 v[110:111], v2 offset:1352
    v_mfma_f32_16x16x32_bf16 v[20:23], v[128:131], v[124:127], v[20:23]
    ds_read_b64 v[136:137], v2 offset:1856
    s_waitcnt lgkmcnt(13)
    v_mfma_f32_16x16x32_bf16 v[28:31], v[112:115], v[152:155], v[28:31]
    ds_read_b64 v[138:139], v2 offset:1864
    v_mfma_f32_16x16x32_bf16 v[24:27], v[112:115], v[124:127], v[24:27]
    ds_read_b64 v[164:165], v2 offset:2368
    s_waitcnt lgkmcnt(13)
    v_mfma_f32_16x16x32_bf16 v[32:35], v[156:159], v[152:155], v[32:35]
    ds_read_b64 v[166:167], v2 offset:2376
    v_mfma_f32_16x16x32_bf16 v[28:31], v[156:159], v[124:127], v[28:31]
    ds_read_b64 v[120:121], v2 offset:2880
    s_waitcnt lgkmcnt(13)
    v_mfma_f32_16x16x32_bf16 v[36:39], v[132:135], v[152:155], v[36:39]
    ds_read_b64 v[122:123], v2 offset:2888
    v_mfma_f32_16x16x32_bf16 v[32:35], v[132:135], v[124:127], v[32:35]
    ds_read_b64 v[140:141], v2 offset:3392
    s_waitcnt lgkmcnt(13)
    v_mfma_f32_16x16x32_bf16 v[40:43], v[116:119], v[152:155], v[40:43]
    ds_read_b64 v[142:143], v2 offset:3400
    v_mfma_f32_16x16x32_bf16 v[36:39], v[116:119], v[124:127], v[36:39]
    ds_read_b64 v[128:129], v2 offset:3904
    s_waitcnt lgkmcnt(13)
    v_mfma_f32_16x16x32_bf16 v[40:43], v[144:147], v[124:127], v[40:43]
    ds_read_b64 v[130:131], v2 offset:3912
    s_waitcnt lgkmcnt(13)
    v_mfma_f32_16x16x32_bf16 v[16:19], v[84:87], v[160:163], v[16:19]
    ds_read_b128 v[112:115], v4 offset:3456
    s_waitcnt lgkmcnt(13)
    v_mfma_f32_16x16x32_bf16 v[12:15], v[84:87], v[148:151], v[12:15]
    ds_read_b128 v[156:159], v4 offset:3968
    v_mfma_f32_16x16x32_bf16 v[20:23], v[88:91], v[160:163], v[20:23]
    ds_read_b64 v[132:133], v2 offset:1408
    v_mfma_f32_16x16x32_bf16 v[16:19], v[88:91], v[148:151], v[16:19]
    s_waitcnt lgkmcnt(13)
    v_mfma_f32_16x16x32_bf16 v[24:27], v[108:111], v[160:163], v[24:27]
    ds_read_b64 v[134:135], v2 offset:1416
    v_mfma_f32_16x16x32_bf16 v[20:23], v[108:111], v[148:151], v[20:23]
    ds_read_b64 v[152:153], v2 offset:1920
    s_waitcnt lgkmcnt(13)
    v_mfma_f32_16x16x32_bf16 v[28:31], v[136:139], v[160:163], v[28:31]
    ds_read_b64 v[154:155], v2 offset:1928
    v_mfma_f32_16x16x32_bf16 v[24:27], v[136:139], v[148:151], v[24:27]
    ds_read_b64 v[116:117], v2 offset:2432
    s_waitcnt lgkmcnt(13)
    v_mfma_f32_16x16x32_bf16 v[32:35], v[164:167], v[160:163], v[32:35]
    ds_read_b64 v[118:119], v2 offset:2440
    v_mfma_f32_16x16x32_bf16 v[28:31], v[164:167], v[148:151], v[28:31]
    ds_read_b64 v[144:145], v2 offset:2944
    s_waitcnt lgkmcnt(13)
    v_mfma_f32_16x16x32_bf16 v[36:39], v[120:123], v[160:163], v[36:39]
    ds_read_b64 v[146:147], v2 offset:2952
    v_mfma_f32_16x16x32_bf16 v[32:35], v[120:123], v[148:151], v[32:35]
    ds_read_b64 v[124:125], v2 offset:3456
    s_waitcnt lgkmcnt(13)
    v_mfma_f32_16x16x32_bf16 v[40:43], v[140:143], v[160:163], v[40:43]
    ds_read_b64 v[126:127], v2 offset:3464
    v_mfma_f32_16x16x32_bf16 v[36:39], v[140:143], v[148:151], v[36:39]
    ds_read_b64 v[108:109], v2 offset:3968
    s_waitcnt lgkmcnt(13)
    v_mfma_f32_16x16x32_bf16 v[40:43], v[128:131], v[148:151], v[40:43]
    ds_read_b64 v[110:111], v2 offset:3976
    s_waitcnt lgkmcnt(13)
    v_mfma_f32_16x16x32_bf16 v[16:19], v[92:95], v[112:115], v[16:19]
    ds_read_b128 v[136:139], v4 offset:3520
    s_waitcnt lgkmcnt(13)
    v_mfma_f32_16x16x32_bf16 v[12:15], v[92:95], v[156:159], v[12:15]
    ds_read_b128 v[164:167], v4 offset:4032
    v_mfma_f32_16x16x32_bf16 v[20:23], v[96:99], v[112:115], v[20:23]
    ds_read_b64 v[120:121], v2 offset:1472
    v_mfma_f32_16x16x32_bf16 v[16:19], v[96:99], v[156:159], v[16:19]
    s_waitcnt lgkmcnt(13)
    v_mfma_f32_16x16x32_bf16 v[24:27], v[132:135], v[112:115], v[24:27]
    ds_read_b64 v[122:123], v2 offset:1480
    v_mfma_f32_16x16x32_bf16 v[20:23], v[132:135], v[156:159], v[20:23]
    ds_read_b64 v[160:161], v2 offset:1984
    s_waitcnt lgkmcnt(13)
    v_mfma_f32_16x16x32_bf16 v[28:31], v[152:155], v[112:115], v[28:31]
    ds_read_b64 v[162:163], v2 offset:1992
    v_mfma_f32_16x16x32_bf16 v[24:27], v[152:155], v[156:159], v[24:27]
    ds_read_b64 v[140:141], v2 offset:2496
    s_waitcnt lgkmcnt(13)
    v_mfma_f32_16x16x32_bf16 v[32:35], v[116:119], v[112:115], v[32:35]
    ds_read_b64 v[142:143], v2 offset:2504
    v_mfma_f32_16x16x32_bf16 v[28:31], v[116:119], v[156:159], v[28:31]
    ds_read_b64 v[128:129], v2 offset:3008
    s_waitcnt lgkmcnt(13)
    v_mfma_f32_16x16x32_bf16 v[36:39], v[144:147], v[112:115], v[36:39]
    ds_read_b64 v[130:131], v2 offset:3016
    v_mfma_f32_16x16x32_bf16 v[32:35], v[144:147], v[156:159], v[32:35]
    ds_read_b64 v[148:149], v2 offset:3520
    s_waitcnt lgkmcnt(13)
    v_mfma_f32_16x16x32_bf16 v[40:43], v[124:127], v[112:115], v[40:43]
    ds_read_b64 v[150:151], v2 offset:3528
    v_mfma_f32_16x16x32_bf16 v[36:39], v[124:127], v[156:159], v[36:39]
    ds_read_b32 v1, v3 offset:4
    s_waitcnt lgkmcnt(13)
    v_mfma_f32_16x16x32_bf16 v[40:43], v[108:111], v[156:159], v[40:43]
    ds_read_b64 v[132:133], v2 offset:4032
    s_waitcnt lgkmcnt(13)
    v_mfma_f32_16x16x32_bf16 v[16:19], v[100:103], v[136:139], v[16:19]
    ds_read_b64 v[134:135], v2 offset:4040
    s_waitcnt lgkmcnt(13)
    v_mfma_f32_16x16x32_bf16 v[12:15], v[100:103], v[164:167], v[12:15]
    ds_read_b64 v[152:153], v2 offset:1024
    v_mfma_f32_16x16x32_bf16 v[20:23], v[104:107], v[136:139], v[20:23]
    ds_read_b64 v[154:155], v2 offset:1032
    v_mfma_f32_16x16x32_bf16 v[16:19], v[104:107], v[164:167], v[16:19]
    s_waitcnt lgkmcnt(4)
    v_readfirstlane_b32 s7, v1
    s_nop 0
    s_cmp_ge_u32 s7, 4
    s_cbranch_scc0 L_xw2
L_xr2:
    v_mfma_f32_16x16x32_bf16 v[24:27], v[120:123], v[136:139], v[24:27]
    ds_read_b128 v[116:119], v4 offset:2048
    v_mfma_f32_16x16x32_bf16 v[20:23], v[120:123], v[164:167], v[20:23]
    ds_read_b128 v[144:147], v4 offset:2560
    v_mfma_f32_16x16x32_bf16 v[28:31], v[160:163], v[136:139], v[28:31]
    ds_read_b64 v[112:113], v2 offset:1536
    v_cvt_pk_bf16_f32 v6, v12, v13
    v_cvt_pk_bf16_f32 v7, v14, v15
    v_cvt_pk_bf16_f32 v8, v16, v17
    v_cvt_pk_bf16_f32 v9, v18, v19
    v_mfma_f32_16x16x32_bf16 v[24:27], v[160:163], v[164:167], v[24:27]
    ds_read_b64 v[114:115], v2 offset:1544
    v_mfma_f32_16x16x32_bf16 v[32:35], v[140:143], v[136:139], v[32:35]
    v_add_u32 v0, 12392, v5
    ds_write2_b32 v0, v6, v7 offset0:0 offset1:32
    v_mfma_f32_16x16x32_bf16 v[28:31], v[140:143], v[164:167], v[28:31]
    v_add_u32 v0, 16616, v5
    ds_write2_b32 v0, v8, v9 offset0:0 offset1:32
    v_mfma_f32_16x16x32_bf16 v[36:39], v[128:131], v[136:139], v[36:39]
    s_mov_b64 exec, 1
    ds_add_u64 v3, v[10:11] offset:16
    s_mov_b64 exec, -1
    v_mfma_f32_16x16x32_bf16 v[32:35], v[128:131], v[164:167], v[32:35]
    ds_read_b64 v[124:125], v2 offset:2048
    v_mfma_f32_16x16x32_bf16 v[40:43], v[148:151], v[136:139], v[40:43]
    ds_read_b64 v[126:127], v2 offset:2056
    v_mfma_f32_16x16x32_bf16 v[36:39], v[148:151], v[164:167], v[36:39]
    ds_read_b64 v[108:109], v2 offset:2560
    s_waitcnt lgkmcnt(12)
    v_mfma_f32_16x16x32_bf16 v[40:43], v[132:135], v[164:167], v[40:43]
    ds_read_b64 v[110:111], v2 offset:2568
    s_waitcnt lgkmcnt(10)
    v_mfma_f32_16x16x32_bf16 v[24:27], v[44:47], v[116:119], v[24:27]
    ds_read_b128 v[156:159], v4 offset:2112
    s_waitcnt lgkmcnt(10)
    v_mfma_f32_16x16x32_bf16 v[20:23], v[44:47], v[144:147], v[20:23]
    ds_read_b128 v[120:123], v4 offset:2624
    v_mfma_f32_16x16x32_bf16 v[28:31], v[48:51], v[116:119], v[28:31]
    ds_read_b64 v[160:161], v2 offset:1088
    v_mfma_f32_16x16x32_bf16 v[24:27], v[48:51], v[144:147], v[24:27]
    ds_read_b64 v[162:163], v2 offset:1096
    v_mfma_f32_16x16x32_bf16 v[32:35], v[152:155], v[116:119], v[32:35]
    ds_read_b64 v[140:141], v2 offset:1600
    v_mfma_f32_16x16x32_bf16 v[28:31], v[152:155], v[144:147], v[28:31]
    ds_read_b64 v[142:143], v2 offset:1608
    s_waitcnt lgkmcnt(13)
    v_mfma_f32_16x16x32_bf16 v[36:39], v[112:115], v[116:119], v[36:39]
    ds_read_b64 v[128:129], v2 offset:2112
    v_mfma_f32_16x16x32_bf16 v[32:35], v[112:115], v[144:147], v[32:35]
    ds_read_b64 v[130:131], v2 offset:2120
    s_waitcnt lgkmcnt(10)
    v_mfma_f32_16x16x32_bf16 v[40:43], v[124:127], v[116:119], v[40:43]
    ds_read_b64 v[136:137], v2 offset:2624
    v_mfma_f32_16x16x32_bf16 v[36:39], v[124:127], v[144:147], v[36:39]
    ds_read_b64 v[138:139], v2 offset:2632
    s_waitcnt lgkmcnt(10)
    v_mfma_f32_16x16x32_bf16 v[40:43], v[108:111], v[144:147], v[40:43]
    ds_read_b128 v[148:151], v4 offset:2176
    s_waitcnt lgkmcnt(10)
    v_mfma_f32_16x16x32_bf16 v[24:27], v[52:55], v[156:159], v[24:27]
    ds_read_b128 v[132:135], v4 offset:2688
    s_waitcnt lgkmcnt(10)
    v_mfma_f32_16x16x32_bf16 v[20:23], v[52:55], v[120:123], v[20:23]
    ds_read_b64 v[164:165], v2 offset:1152
    v_mfma_f32_16x16x32_bf16 v[28:31], v[56:59], v[156:159], v[28:31]
    ds_read_b64 v[166:167], v2 offset:1160
    v_mfma_f32_16x16x32_bf16 v[24:27], v[56:59], v[120:123], v[24:27]
    ds_read_b64 v[152:153], v2 offset:1664
    s_waitcnt lgkmcnt(11)
    v_mfma_f32_16x16x32_bf16 v[32:35], v[160:163], v[156:159], v[32:35]
    ds_read_b64 v[154:155], v2 offset:1672
    v_mfma_f32_16x16x32_bf16 v[28:31], v[160:163], v[120:123], v[28:31]
    ds_read_b64 v[112:113], v2 offset:2176
    s_waitcnt lgkmcnt(11)
    v_mfma_f32_16x16x32_bf16 v[36:39], v[140:143], v[156:159], v[36:39]
    ds_read_b64 v[114:115], v2 offset:2184
    v_mfma_f32_16x16x32_bf16 v[32:35], v[140:143], v[120:123], v[32:35]
    ds_read_b64 v[116:117], v2 offset:2688
    s_waitcnt lgkmcnt(11)
    v_mfma_f32_16x16x32_bf16 v[40:43], v[128:131], v[156:159], v[40:43]
    ds_read_b64 v[118:119], v2 offset:2696
    v_mfma_f32_16x16x32_bf16 v[36:39], v[128:131], v[120:123], v[36:39]
    ds_read_b128 v[124:127], v4 offset:2240
    s_waitcnt lgkmcnt(11)
    v_mfma_f32_16x16x32_bf16 v[40:43], v[136:139], v[120:123], v[40:43]
    ds_read_b128 v[108:111], v4 offset:2752
    s_waitcnt lgkmcnt(11)
    v_mfma_f32_16x16x32_bf16 v[24:27], v[60:63], v[148:151], v[24:27]
    ds_read_b64 v[144:145], v2 offset:1216
    s_waitcnt lgkmcnt(11)
    v_mfma_f32_16x16x32_bf16 v[20:23], v[60:63], v[132:135], v[20:23]
    ds_read_b64 v[146:147], v2 offset:1224
    v_mfma_f32_16x16x32_bf16 v[28:31], v[64:67], v[148:151], v[28:31]
    ds_read_b64 v[160:161], v2 offset:1728
    v_mfma_f32_16x16x32_bf16 v[24:27], v[64:67], v[132:135], v[24:27]
    ds_read_b64 v[162:163], v2 offset:1736
    s_waitcnt lgkmcnt(12)
    v_mfma_f32_16x16x32_bf16 v[32:35], v[164:167], v[148:151], v[32:35]
    ds_read_b64 v[140:141], v2 offset:2240
    v_mfma_f32_16x16x32_bf16 v[28:31], v[164:167], v[132:135], v[28:31]
    ds_read_b64 v[142:143], v2 offset:2248
    s_waitcnt lgkmcnt(12)
    v_mfma_f32_16x16x32_bf16 v[36:39], v[152:155], v[148:151], v[36:39]
    ds_read_b64 v[156:157], v2 offset:2752
    v_mfma_f32_16x16x32_bf16 v[32:35], v[152:155], v[132:135], v[32:35]
    ds_read_b64 v[158:159], v2 offset:2760
    s_waitcnt lgkmcnt(12)
    v_mfma_f32_16x16x32_bf16 v[40:43], v[112:115], v[148:151], v[40:43]
    ds_read_b128 v[128:131], v4 offset:2304
    v_mfma_f32_16x16x32_bf16 v[36:39], v[112:115], v[132:135], v[36:39]
    ds_read_b128 v[136:139], v4 offset:2816
    s_waitcnt lgkmcnt(12)
    v_mfma_f32_16x16x32_bf16 v[40:43], v[116:119], v[132:135], v[40:43]
    ds_read_b64 v[120:121], v2 offset:1280
    s_waitcnt lgkmcnt(12)
    v_mfma_f32_16x16x32_bf16 v[24:27], v[68:71], v[124:127], v[24:27]
    ds_read_b64 v[122:123], v2 offset:1288
    s_waitcnt lgkmcnt(12)
    v_mfma_f32_16x16x32_bf16 v[20:23], v[68:71], v[108:111], v[20:23]
    ds_read_b64 v[164:165], v2 offset:1792
    v_mfma_f32_16x16x32_bf16 v[28:31], v[72:75], v[124:127], v[28:31]
    ds_read_b64 v[166:167], v2 offset:1800
    v_mfma_f32_16x16x32_bf16 v[24:27], v[72:75], v[108:111], v[24:27]
    ds_read_b64 v[152:153], v2 offset:2304
    s_waitcnt lgkmcnt(13)
    v_mfma_f32_16x16x32_bf16 v[32:35], v[144:147], v[124:127], v[32:35]
    ds_read_b64 v[154:155], v2 offset:2312
    v_mfma_f32_16x16x32_bf16 v[28:31], v[144:147], v[108:111], v[28:31]
    ds_read_b64 v[148:149], v2 offset:2816
    s_waitcnt lgkmcnt(13)
    v_mfma_f32_16x16x32_bf16 v[36:39], v[160:163], v[124:127], v[36:39]
    ds_read_b64 v[150:151], v2 offset:2824
    v_mfma_f32_16x16x32_bf16 v[32:35], v[160:163], v[108:111], v[32:35]
    ds_read_b128 v[112:115], v4 offset:2368
    s_waitcnt lgkmcnt(13)
    v_mfma_f32_16x16x32_bf16 v[40:43], v[140:143], v[124:127], v[40:43]
    ds_read_b128 v[116:119], v4 offset:2880
    v_mfma_f32_16x16x32_bf16 v[36:39], v[140:143], v[108:111], v[36:39]
    ds_read_b64 v[132:133], v2 offset:1344
    s_waitcnt lgkmcnt(13)
    v_mfma_f32_16x16x32_bf16 v[40:43], v[156:159], v[108:111], v[40:43]
    ds_read_b64 v[134:135], v2 offset:1352
    s_waitcnt lgkmcnt(13)
    v_mfma_f32_16x16x32_bf16 v[24:27], v[76:79], v[128:131], v[24:27]
    ds_read_b64 v[144:145], v2 offset:1856
    s_waitcnt lgkmcnt(13)
    v_mfma_f32_16x16x32_bf16 v[20:23], v[76:79], v[136:139], v[20:23]
    ds_read_b64 v[146:147], v2 offset:1864
    v_mfma_f32_16x16x32_bf16 v[28:31], v[80:83], v[128:131], v[28:31]
    ds_read_b64 v[160:161], v2 offset:2368
    v_mfma_f32_16x16x32_bf16 v[24:27], v[80:83], v[136:139], v[24:27]
    s_waitcnt lgkmcnt(13)
    v_mfma_f32_16x16x32_bf16 v[32:35], v[120:123], v[128:131], v[32:35]
    ds_read_b64 v[162:163], v2 offset:2376
    v_mfma_f32_16x16x32_bf16 v[28:31], v[120:123], v[136:139], v[28:31]
    ds_read_b64 v[124:125], v2 offset:2880
    s_waitcnt lgkmcnt(13)
    v_mfma_f32_16x16x32_bf16 v[36:39], v[164:167], v[128:131], v[36:39]
    ds_read_b64 v[126:127], v2 offset:2888
    v_mfma_f32_16x16x32_bf16 v[32:35], v[164:167], v[136:139], v[32:35]
    ds_read_b128 v[140:143], v4 offset:2432
    s_waitcnt lgkmcnt(13)
    v_mfma_f32_16x16x32_bf16 v[40:43], v[152:155], v[128:131], v[40:43]
    ds_read_b128 v[156:159], v4 offset:2944
    v_mfma_f32_16x16x32_bf16 v[36:39], v[152:155], v[136:139], v[36:39]
    ds_read_b64 v[108:109], v2 offset:1408
    s_waitcnt lgkmcnt(13)
    v_mfma_f32_16x16x32_bf16 v[40:43], v[148:151], v[136:139], v[40:43]
    ds_read_b64 v[110:111], v2 offset:1416
    s_waitcnt lgkmcnt(13)
    v_mfma_f32_16x16x32_bf16 v[24:27], v[84:87], v[112:115], v[24:27]
    ds_read_b64 v[120:121], v2 offset:1920
    s_waitcnt lgkmcnt(13)
    v_mfma_f32_16x16x32_bf16 v[20:23], v[84:87], v[116:119], v[20:23]
    ds_read_b64 v[122:123], v2 offset:1928
    v_mfma_f32_16x16x32_bf16 v[28:31], v[88:91], v[112:115], v[28:31]
    ds_read_b64 v[164:165], v2 offset:2432
    v_mfma_f32_16x16x32_bf16 v[24:27], v[88:91], v[116:119], v[24:27]
    s_waitcnt lgkmcnt(13)
    v_mfma_f32_16x16x32_bf16 v[32:35], v[132:135], v[112:115], v[32:35]
    ds_read_b64 v[166:167], v2 offset:2440
    v_mfma_f32_16x16x32_bf16 v[28:31], v[132:135], v[116:119], v[28:31]
    ds_read_b64 v[128:129], v2 offset:2944
    s_waitcnt lgkmcnt(13)
    v_mfma_f32_16x16x32_bf16 v[36:39], v[144:147], v[112:115], v[36:39]
    ds_read_b64 v[130:131], v2 offset:2952
    v_mfma_f32_16x16x32_bf16 v[32:35], v[144:147], v[116:119], v[32:35]
    ds_read_b128 v[152:155], v4 offset:2496
    s_waitcnt lgkmcnt(13)
    v_mfma_f32_16x16x32_bf16 v[40:43], v[160:163], v[112:115], v[40:43]
    ds_read_b128 v[148:151], v4 offset:3008
    v_mfma_f32_16x16x32_bf16 v[36:39], v[160:163], v[116:119], v[36:39]
    ds_read_b64 v[136:137], v2 offset:1472
    s_waitcnt lgkmcnt(13)
    v_mfma_f32_16x16x32_bf16 v[40:43], v[124:127], v[116:119], v[40:43]
    ds_read_b64 v[138:139], v2 offset:1480
    s_waitcnt lgkmcnt(13)
    v_mfma_f32_16x16x32_bf16 v[24:27], v[92:95], v[140:143], v[24:27]
    ds_read_b64 v[132:133], v2 offset:1984
    s_waitcnt lgkmcnt(13)
    v_mfma_f32_16x16x32_bf16 v[20:23], v[92:95], v[156:159], v[20:23]
    ds_read_b64 v[134:135], v2 offset:1992
    v_mfma_f32_16x16x32_bf16 v[28:31], v[96:99], v[140:143], v[28:31]
    ds_read_b64 v[144:145], v2 offset:2496
    v_mfma_f32_16x16x32_bf16 v[24:27], v[96:99], v[156:159], v[24:27]
    s_waitcnt lgkmcnt(13)
    v_mfma_f32_16x16x32_bf16 v[32:35], v[108:111], v[140:143], v[32:35]
    ds_read_b64 v[146:147], v2 offset:2504
    v_mfma_f32_16x16x32_bf16 v[28:31], v[108:111], v[156:159], v[28:31]
    ds_read_b32 v1, v3 offset:8
    s_waitcnt lgkmcnt(13)
    v_mfma_f32_16x16x32_bf16 v[36:39], v[120:123], v[140:143], v[36:39]
    ds_read_b64 v[112:113], v2 offset:3008
    v_mfma_f32_16x16x32_bf16 v[32:35], v[120:123], v[156:159], v[32:35]
    ds_read_b64 v[114:115], v2 offset:3016
    s_waitcnt lgkmcnt(13)
    v_mfma_f32_16x16x32_bf16 v[40:43], v[164:167], v[140:143], v[40:43]
    ds_read_b64 v[160:161], v2 offset:1024
    v_mfma_f32_16x16x32_bf16 v[36:39], v[164:167], v[156:159], v[36:39]
    ds_read_b64 v[162:163], v2 offset:1032
    s_waitcnt lgkmcnt(13)
    v_mfma_f32_16x16x32_bf16 v[40:43], v[128:131], v[156:159], v[40:43]
    ds_read_b64 v[124:125], v2 offset:1536
    s_waitcnt lgkmcnt(5)
    v_readfirstlane_b32 s7, v1
    s_nop 0
    s_cmp_ge_u32 s7, 4
    s_cbranch_scc0 L_xw3
L_xr3:
    v_mfma_f32_16x16x32_bf16 v[24:27], v[100:103], v[152:155], v[24:27]
    ds_read_b64 v[126:127], v2 offset:1544
    v_mfma_f32_16x16x32_bf16 v[20:23], v[100:103], v[148:151], v[20:23]
    ds_read_b128 v[116:119], v4 offset:1024
    v_mfma_f32_16x16x32_bf16 v[28:31], v[104:107], v[152:155], v[28:31]
    ds_read_b128 v[108:111], v4 offset:1536
    v_mfma_f32_16x16x32_bf16 v[24:27], v[104:107], v[148:151], v[24:27]
    ds_read_b128 v[120:123], v4 offset:1088
    v_mfma_f32_16x16x32_bf16 v[32:35], v[136:139], v[152:155], v[32:35]
    ds_read_b128 v[140:143], v4 offset:1600
    v_mfma_f32_16x16x32_bf16 v[28:31], v[136:139], v[148:151], v[28:31]
    ds_read_b64 v[164:165], v2 offset:1088
    v_mfma_f32_16x16x32_bf16 v[36:39], v[132:135], v[152:155], v[36:39]
    ds_read_b64 v[166:167], v2 offset:1096
    v_cvt_pk_bf16_f32 v6, v20, v21
    v_cvt_pk_bf16_f32 v7, v22, v23
    v_cvt_pk_bf16_f32 v8, v24, v25
    v_cvt_pk_bf16_f32 v9, v26, v27
    v_mfma_f32_16x16x32_bf16 v[32:35], v[132:135], v[148:151], v[32:35]
    v_add_u32 v0, 11368, v5
    ds_write2_b32 v0, v6, v7 offset0:0 offset1:32
    v_mfma_f32_16x16x32_bf16 v[40:43], v[144:147], v[152:155], v[40:43]
    v_add_u32 v0, 15592, v5
    ds_write2_b32 v0, v8, v9 offset0:0 offset1:32
    v_mfma_f32_16x16x32_bf16 v[36:39], v[144:147], v[148:151], v[36:39]
    s_mov_b64 exec, 1
    ds_add_u64 v3, v[10:11] offset:24
    s_mov_b64 exec, -1
    s_waitcnt lgkmcnt(13)
    v_mfma_f32_16x16x32_bf16 v[40:43], v[112:115], v[148:151], v[40:43]
    ds_read_b64 v[128:129], v2 offset:1600
    s_setprio 1
    s_waitcnt lgkmcnt(9)
    v_mfma_f32_16x16x32_bf16 v[32:35], v[44:47], v[116:119], v[32:35]
    ds_read_b64 v[130:131], v2 offset:1608
    s_waitcnt lgkmcnt(9)
    v_mfma_f32_16x16x32_bf16 v[28:31], v[44:47], v[108:111], v[28:31]
    ds_read_b128 v[156:159], v4 offset:1152
    v_mfma_f32_16x16x32_bf16 v[36:39], v[48:51], v[116:119], v[36:39]
    ds_read_b128 v[136:139], v4 offset:1664
    v_mfma_f32_16x16x32_bf16 v[32:35], v[48:51], v[108:111], v[32:35]
    ds_read_b64 v[132:133], v2 offset:1152
    v_mfma_f32_16x16x32_bf16 v[40:43], v[160:163], v[116:119], v[40:43]
    ds_read_b64 v[134:135], v2 offset:1160
    v_mfma_f32_16x16x32_bf16 v[36:39], v[160:163], v[108:111], v[36:39]
    ds_read_b64 v[152:153], v2 offset:1664
    v_mfma_f32_16x16x32_bf16 v[40:43], v[124:127], v[108:111], v[40:43]
    ds_read_b64 v[154:155], v2 offset:1672
    s_waitcnt lgkmcnt(14)
    v_mfma_f32_16x16x32_bf16 v[32:35], v[52:55], v[120:123], v[32:35]
    ds_read_b128 v[144:147], v4 offset:1216
    s_waitcnt lgkmcnt(14)
    v_mfma_f32_16x16x32_bf16 v[28:31], v[52:55], v[140:143], v[28:31]
    ds_read_b128 v[112:115], v4 offset:1728
    v_mfma_f32_16x16x32_bf16 v[36:39], v[56:59], v[120:123], v[36:39]
    v_mfma_f32_16x16x32_bf16 v[32:35], v[56:59], v[140:143], v[32:35]
    s_waitcnt lgkmcnt(13)
    v_mfma_f32_16x16x32_bf16 v[40:43], v[164:167], v[120:123], v[40:43]
    ds_read_b64 v[148:149], v2 offset:1216
    v_mfma_f32_16x16x32_bf16 v[36:39], v[164:167], v[140:143], v[36:39]
    ds_read_b64 v[150:151], v2 offset:1224
    s_waitcnt lgkmcnt(10)
    v_mfma_f32_16x16x32_bf16 v[40:43], v[128:131], v[140:143], v[40:43]
    ds_read_b64 v[116:117], v2 offset:1728
    s_waitcnt lgkmcnt(10)
    v_mfma_f32_16x16x32_bf16 v[32:35], v[60:63], v[156:159], v[32:35]
    ds_read_b64 v[118:119], v2 offset:1736
    s_waitcnt lgkmcnt(10)
    v_mfma_f32_16x16x32_bf16 v[28:31], v[60:63], v[136:139], v[28:31]
    ds_read_b128 v[160:163], v4 offset:1280
    v_mfma_f32_16x16x32_bf16 v[36:39], v[64:67], v[156:159], v[36:39]
    ds_read_b128 v[124:127], v4 offset:1792
    v_mfma_f32_16x16x32_bf16 v[32:35], v[64:67], v[136:139], v[32:35]
    ds_read_b64 v[108:109], v2 offset:1280
    s_waitcnt lgkmcnt(11)
    v_mfma_f32_16x16x32_bf16 v[40:43], v[132:135], v[156:159], v[40:43]
    ds_read_b64 v[110:111], v2 offset:1288
    v_mfma_f32_16x16x32_bf16 v[36:39], v[132:135], v[136:139], v[36:39]
    ds_read_b64 v[120:121], v2 offset:1792
    s_waitcnt lgkmcnt(11)
    v_mfma_f32_16x16x32_bf16 v[40:43], v[152:155], v[136:139], v[40:43]
    ds_read_b64 v[122:123], v2 offset:1800
    s_waitcnt lgkmcnt(11)
    v_mfma_f32_16x16x32_bf16 v[32:35], v[68:71], v[144:147], v[32:35]
    ds_read_b128 v[164:167], v4 offset:1344
    s_waitcnt lgkmcnt(11)
    v_mfma_f32_16x16x32_bf16 v[28:31], v[68:71], v[112:115], v[28:31]
    ds_read_b128 v[128:131], v4 offset:1856
    v_mfma_f32_16x16x32_bf16 v[36:39], v[72:75], v[144:147], v[36:39]
    ds_read_b64 v[140:141], v2 offset:1344
    v_mfma_f32_16x16x32_bf16 v[32:35], v[72:75], v[112:115], v[32:35]
    ds_read_b64 v[142:143], v2 offset:1352
    s_waitcnt lgkmcnt(12)
    v_mfma_f32_16x16x32_bf16 v[40:43], v[148:151], v[144:147], v[40:43]
    ds_read_b64 v[156:157], v2 offset:1856
    v_mfma_f32_16x16x32_bf16 v[36:39], v[148:151], v[112:115], v[36:39]
    ds_read_b64 v[158:159], v2 offset:1864
    s_waitcnt lgkmcnt(12)
    v_mfma_f32_16x16x32_bf16 v[40:43], v[116:119], v[112:115], v[40:43]
    ds_read_b128 v[132:135], v4 offset:1408
    s_waitcnt lgkmcnt(12)
    v_mfma_f32_16x16x32_bf16 v[32:35], v[76:79], v[160:163], v[32:35]
    ds_read_b128 v[152:155], v4 offset:1920
    s_waitcnt lgkmcnt(12)
    v_mfma_f32_16x16x32_bf16 v[28:31], v[76:79], v[124:127], v[28:31]
    ds_read_b64 v[136:137], v2 offset:1408
    v_mfma_f32_16x16x32_bf16 v[36:39], v[80:83], v[160:163], v[36:39]
    ds_read_b64 v[138:139], v2 offset:1416
    v_mfma_f32_16x16x32_bf16 v[32:35], v[80:83], v[124:127], v[32:35]
    ds_read_b64 v[144:145], v2 offset:1920
    s_waitcnt lgkmcnt(13)
    v_mfma_f32_16x16x32_bf16 v[40:43], v[108:111], v[160:163], v[40:43]
    ds_read_b64 v[146:147], v2 offset:1928
    v_mfma_f32_16x16x32_bf16 v[36:39], v[108:111], v[124:127], v[36:39]
    ds_read_b128 v[148:151], v4 offset:1472
    s_waitcnt lgkmcnt(13)
    v_mfma_f32_16x16x32_bf16 v[40:43], v[120:123], v[124:127], v[40:43]
    ds_read_b128 v[116:119], v4 offset:1984
    s_waitcnt lgkmcnt(13)
    v_mfma_f32_16x16x32_bf16 v[32:35], v[84:87], v[164:167], v[32:35]
    ds_read_b64 v[112:113], v2 offset:1472
    s_waitcnt lgkmcnt(13)
    v_mfma_f32_16x16x32_bf16 v[28:31], v[84:87], v[128:131], v[28:31]
    ds_read_b64 v[114:115], v2 offset:1480
    v_mfma_f32_16x16x32_bf16 v[36:39], v[88:91], v[164:167], v[36:39]
    ds_read_b64 v[160:161], v2 offset:1984
    v_mfma_f32_16x16x32_bf16 v[32:35], v[88:91], v[128:131], v[32:35]
    s_waitcnt lgkmcnt(13)
    v_mfma_f32_16x16x32_bf16 v[40:43], v[140:143], v[164:167], v[40:43]
    ds_read_b64 v[162:163], v2 offset:1992
    v_mfma_f32_16x16x32_bf16 v[36:39], v[140:143], v[128:131], v[36:39]
    ds_read_b32 v1, v3 offset:12
    s_waitcnt lgkmcnt(13)
    v_mfma_f32_16x16x32_bf16 v[40:43], v[156:159], v[128:131], v[40:43]
    s_waitcnt lgkmcnt(12)
    v_mfma_f32_16x16x32_bf16 v[32:35], v[92:95], v[132:135], v[32:35]
    s_waitcnt lgkmcnt(11)
    v_mfma_f32_16x16x32_bf16 v[28:31], v[92:95], v[152:155], v[28:31]
    v_mfma_f32_16x16x32_bf16 v[36:39], v[96:99], v[132:135], v[36:39]
    s_waitcnt lgkmcnt(0)
    v_readfirstlane_b32 s7, v1
    s_nop 0
    s_cmp_ge_u32 s7, 4
    s_cbranch_scc0 L_xw4
L_xr4:
    v_mfma_f32_16x16x32_bf16 v[32:35], v[96:99], v[152:155], v[32:35]
    ds_read_b128 v[108:111], v4 offset:512
    v_mfma_f32_16x16x32_bf16 v[40:43], v[136:139], v[132:135], v[40:43]
    ds_read_b128 v[120:123], v4 offset:576
    v_mfma_f32_16x16x32_bf16 v[36:39], v[136:139], v[152:155], v[36:39]
    ds_read_b128 v[124:127], v4 offset:640
    v_mfma_f32_16x16x32_bf16 v[40:43], v[144:147], v[152:155], v[40:43]
    ds_read_b128 v[164:167], v4 offset:704
    v_mfma_f32_16x16x32_bf16 v[32:35], v[100:103], v[148:151], v[32:35]
    ds_read_b128 v[140:143], v4 offset:768
    v_mfma_f32_16x16x32_bf16 v[28:31], v[100:103], v[116:119], v[28:31]
    ds_read_b128 v[156:159], v4 offset:832
    v_mfma_f32_16x16x32_bf16 v[36:39], v[104:107], v[148:151], v[36:39]
    ds_read_b128 v[128:131], v4 offset:896
    v_mfma_f32_16x16x32_bf16 v[32:35], v[104:107], v[116:119], v[32:35]
    ds_read_b128 v[132:135], v4 offset:960
    v_mfma_f32_16x16x32_bf16 v[40:43], v[112:115], v[148:151], v[40:43]
    ds_read_b128 v[136:139], v4 offset:0
    v_mfma_f32_16x16x32_bf16 v[36:39], v[112:115], v[116:119], v[36:39]
    ds_read_b128 v[144:147], v4 offset:64
    v_mfma_f32_16x16x32_bf16 v[40:43], v[160:163], v[116:119], v[40:43]
    ds_read_b128 v[152:155], v4 offset:128
    v_cvt_pk_bf16_f32 v6, v28, v29
    v_cvt_pk_bf16_f32 v7, v30, v31
    v_cvt_pk_bf16_f32 v8, v32, v33
    v_cvt_pk_bf16_f32 v9, v34, v35
    s_setprio 0
    s_waitcnt lgkmcnt(10)
    v_mfma_f32_16x16x32_bf16 v[36:39], v[44:47], v[108:111], v[36:39]
    v_add_u32 v0, 10344, v5
    ds_write2_b32 v0, v6, v7 offset0:0 offset1:32
    s_waitcnt lgkmcnt(10)
    v_mfma_f32_16x16x32_bf16 v[36:39], v[52:55], v[120:123], v[36:39]
    v_add_u32 v0, 14568, v5
    ds_write2_b32 v0, v8, v9 offset0:0 offset1:32
    s_waitcnt lgkmcnt(10)
    v_mfma_f32_16x16x32_bf16 v[36:39], v[60:63], v[124:127], v[36:39]
    s_mov_b64 exec, 1
    ds_add_u64 v3, v[10:11] offset:32
    s_mov_b64 exec, -1
    s_waitcnt lgkmcnt(10)
    v_mfma_f32_16x16x32_bf16 v[36:39], v[68:71], v[164:167], v[36:39]
    ds_read_b128 v[148:151], v4 offset:192
    s_waitcnt lgkmcnt(10)
    v_mfma_f32_16x16x32_bf16 v[36:39], v[76:79], v[140:143], v[36:39]
    ds_read_b128 v[112:115], v4 offset:256
    s_waitcnt lgkmcnt(10)
    v_mfma_f32_16x16x32_bf16 v[36:39], v[84:87], v[156:159], v[36:39]
    ds_read_b128 v[160:163], v4 offset:320
    s_waitcnt lgkmcnt(10)
    v_mfma_f32_16x16x32_bf16 v[36:39], v[92:95], v[128:131], v[36:39]
    ds_read_b128 v[116:119], v4 offset:384
    s_waitcnt lgkmcnt(10)
    v_mfma_f32_16x16x32_bf16 v[36:39], v[100:103], v[132:135], v[36:39]
    s_waitcnt lgkmcnt(9)
    v_mfma_f32_16x16x32_bf16 v[40:43], v[44:47], v[136:139], v[40:43]
    ds_read_b128 v[136:139], v4 offset:448
    v_mfma_f32_16x16x32_bf16 v[40:43], v[48:51], v[108:111], v[40:43]
    s_waitcnt lgkmcnt(9)
    v_mfma_f32_16x16x32_bf16 v[40:43], v[52:55], v[144:147], v[40:43]
    s_nop 1
    v_cvt_pk_bf16_f32 v6, v36, v37
    v_cvt_pk_bf16_f32 v7, v38, v39
    v_mfma_f32_16x16x32_bf16 v[40:43], v[56:59], v[120:123], v[40:43]
    v_add_u32 v0, 9320, v5
    ds_write2_b32 v0, v6, v7 offset0:0 offset1:32
    s_waitcnt lgkmcnt(9)
    v_mfma_f32_16x16x32_bf16 v[40:43], v[60:63], v[152:155], v[40:43]
    s_mov_b64 exec, 1
    ds_add_u32 v3, v10 offset:40
    s_mov_b64 exec, -1
    v_mfma_f32_16x16x32_bf16 v[40:43], v[64:67], v[124:127], v[40:43]
    s_waitcnt lgkmcnt(6)
    v_mfma_f32_16x16x32_bf16 v[40:43], v[68:71], v[148:151], v[40:43]
    v_mfma_f32_16x16x32_bf16 v[40:43], v[72:75], v[164:167], v[40:43]
    s_waitcnt lgkmcnt(5)
    v_mfma_f32_16x16x32_bf16 v[40:43], v[76:79], v[112:115], v[40:43]
    v_mfma_f32_16x16x32_bf16 v[40:43], v[80:83], v[140:143], v[40:43]
    s_waitcnt lgkmcnt(4)
    v_mfma_f32_16x16x32_bf16 v[40:43], v[84:87], v[160:163], v[40:43]
    v_mfma_f32_16x16x32_bf16 v[40:43], v[88:91], v[156:159], v[40:43]
    s_waitcnt lgkmcnt(3)
    v_mfma_f32_16x16x32_bf16 v[40:43], v[92:95], v[116:119], v[40:43]
    v_mfma_f32_16x16x32_bf16 v[40:43], v[96:99], v[128:131], v[40:43]
    s_waitcnt lgkmcnt(2)
    v_mfma_f32_16x16x32_bf16 v[40:43], v[100:103], v[136:139], v[40:43]
    v_mfma_f32_16x16x32_bf16 v[40:43], v[104:107], v[132:135], v[40:43]
    s_nop 7
    v_cvt_pk_bf16_f32 v6, v40, v41
    v_cvt_pk_bf16_f32 v7, v42, v43
    v_add_u32 v0, 13544, v5
    ds_write2_b32 v0, v6, v7 offset0:0 offset1:32
    s_mov_b64 exec, 1
    ds_add_u32 v3, v10 offset:44
    s_mov_b64 exec, -1
    s_endpgm
L_xw2:
L_spin2:
    ds_read_b32 v1, v3 offset:4
    s_waitcnt lgkmcnt(0)
    v_readfirstlane_b32 s7, v1
    s_nop 0
    s_cmp_ge_u32 s7, 4
    s_cbranch_scc1 L_spun2
    s_sleep 1
    s_sub_u32 s57, s57, 1
    s_cbranch_scc0 L_spin2
    s_mov_b32 s57, 0
L_spun2:
    s_branch L_xr2
L_xw3:
L_spin3:
    ds_read_b32 v1, v3 offset:8
    s_waitcnt lgkmcnt(0)
    v_readfirstlane_b32 s7, v1
    s_nop 0
    s_cmp_ge_u32 s7, 4
    s_cbranch_scc1 L_spun3
    s_sleep 1
    s_sub_u32 s57, s57, 1
    s_cbranch_scc0 L_spin3
    s_mov_b32 s57, 0
L_spun3:
    s_branch L_xr3
L_xw4:
L_spin4:
    ds_read_b32 v1, v3 offset:12
    s_waitcnt lgkmcnt(0)
    v_readfirstlane_b32 s7, v1
    s_nop 0
    s_cmp_ge_u32 s7, 4
    s_cbranch_scc1 L_spun4
    s_sleep 1
    s_sub_u32 s57, s57, 1
    s_cbranch_scc0 L_spin4
    s_mov_b32 s57, 0
L_spun4:
    s_branch L_xr4
L_helperA2:
    v_lshlrev_b32 v10, 2, v2
    v_sub_u32 v4, 4152, v10
    v_add_u32 v5, 61248, v4
    v_bfe_u32 v10, v1, 2, 2
    v_mul_u32_u24 v12, 20432, v10
    v_lshrrev_b32 v10, 5, v2
    v_lshl_add_u32 v12, v10, 3, v12
    v_bfe_u32 v10, v1, 1, 1
    v_lshl_add_u32 v12, v10, 6, v12
    v_and_b32 v10, 1, v1
    v_lshl_add_u32 v12, v10, 7, v12
    v_bfe_u32 v10, v1, 4, 1
    v_lshl_add_u32 v12, v10, 8, v12
    v_add_u32 v12, 12392, v12
    v_mul_u32_u24 v14, 2560, v2
    s_add_u32 s6, s45, 0
    v_add_u32 v14, s6, v14
    v_mov_b32 v7, 0
    v_mov_b32 v8, 1
    v_mov_b32 v9, 0
    v_subrev_u32 v12, 3072, v12
    v_add_u32 v6, 122496, v4
    v_add_u32 v13, 81664, v12
    v_mul_u32_u24 v15, 1280, v2
    v_add_u32 v15, s45, v15
    s_mov_b32 s47, 0
    s_waitcnt lgkmcnt(0)
    s_lshl_b32 s64, s48, 16
    s_and_b32 s65, s48, 0xffff0000
    s_lshl_b32 s66, s49, 16
    s_and_b32 s67, s49, 0xffff0000
    s_lshl_b32 s68, s50, 16
    s_and_b32 s69, s50, 0xffff0000
    s_lshl_b32 s70, s51, 16
    s_and_b32 s71, s51, 0xffff0000
    s_lshl_b32 s72, s52, 16
    s_and_b32 s73, s52, 0xffff0000
    s_lshl_b32 s74, s53, 16
    s_and_b32 s75, s53, 0xffff0000
    s_lshl_b32 s76, s54, 16
    s_and_b32 s77, s54, 0xffff0000
    s_lshl_b32 s78, s55, 16
    s_and_b32 s79, s55, 0xffff0000
    s_lshl_b32 s80, s56, 16
    s_and_b32 s81, s56, 0xffff0000
    s_lshl_b32 s82, s57, 16
    s_and_b32 s83, s57, 0xffff0000
    s_lshl_b32 s84, s58, 16
    s_and_b32 s85, s58, 0xffff0000
    s_lshl_b32 s86, s59, 16
    s_and_b32 s87, s59, 0xffff0000
    s_lshl_b32 s88, s60, 16
    s_and_b32 s89, s60, 0xffff0000
    s_lshl_b32 s90, s61, 16
    s_and_b32 s91, s61, 0xffff0000
    s_lshl_b32 s92, s62, 16
    s_and_b32 s93, s62, 0xffff0000
    s_lshl_b32 s94, s63, 16
    s_and_b32 s95, s63, 0xffff0000
    s_lshr_b32 s48, s64, 16
    s_lshr_b32 s49, s65, 16
    s_lshr_b32 s50, s66, 16
    s_lshr_b32 s51, s67, 16
    s_lshr_b32 s52, s72, 16
    s_lshr_b32 s53, s73, 16
    s_lshr_b32 s54, s74, 16
    s_lshr_b32 s55, s75, 16
    s_lshr_b32 s56, s80, 16
    s_lshr_b32 s57, s81, 16
    s_lshr_b32 s58, s82, 16
    s_lshr_b32 s59, s83, 16
    s_lshr_b32 s60, s88, 16
    s_lshr_b32 s61, s89, 16
    s_lshr_b32 s62, s90, 16
    s_lshr_b32 s63, s91, 16
    s_waitcnt vmcnt(0)
    v_mov_b32_dpp v20, v28 wave_shr:1 row_mask:0xf bank_mask:0xf
    v_mov_b32_dpp v21, v29 wave_shr:1 row_mask:0xf bank_mask:0xf
    v_mov_b32_dpp v22, v30 wave_shr:1 row_mask:0xf bank_mask:0xf
    v_mov_b32_dpp v23, v31 wave_shr:1 row_mask:0xf bank_mask:0xf
    v_mov_b32_dpp v24, v32 wave_shr:1 row_mask:0xf bank_mask:0xf
    v_mov_b32_dpp v25, v33 wave_shr:1 row_mask:0xf bank_mask:0xf
    v_mov_b32_dpp v26, v34 wave_shr:1 row_mask:0xf bank_mask:0xf
    v_mov_b32_dpp v27, v35 wave_shr:1 row_mask:0xf bank_mask:0xf
    v_mov_b32_dpp v16, v24 wave_shr:1 row_mask:0xf bank_mask:0xf
    v_mov_b32_dpp v17, v25 wave_shr:1 row_mask:0xf bank_mask:0xf
    v_mov_b32_dpp v18, v26 wave_shr:1 row_mask:0xf bank_mask:0xf
    v_mov_b32_dpp v19, v27 wave_shr:1 row_mask:0xf bank_mask:0xf
    v_dot2_f32_bf16 v95, v28, s48, 0
    v_dot2_f32_bf16 v96, v32, s48, 0
    v_dot2_f32_bf16 v105, v28, s68, 0
    v_dot2_f32_bf16 v106, v32, s68, 0
    v_dot2_f32_bf16 v95, v24, s49, v95
    v_dot2_f32_bf16 v96, v28, s49, v96
    v_dot2_f32_bf16 v115, v29, s52, 0
    v_dot2_f32_bf16 v116, v33, s52, 0
    v_dot2_f32_bf16 v105, v24, s69, v105
    v_dot2_f32_bf16 v106, v28, s69, v106
    v_dot2_f32_bf16 v125, v29, s76, 0
    v_dot2_f32_bf16 v126, v33, s76, 0
    v_dot2_f32_bf16 v95, v20, s50, v95
    v_dot2_f32_bf16 v96, v24, s50, v96
    v_dot2_f32_bf16 v115, v25, s53, v115
    v_dot2_f32_bf16 v116, v29, s53, v116
    v_dot2_f32_bf16 v105, v20, s70, v105
    v_dot2_f32_bf16 v106, v24, s70, v106
    v_dot2_f32_bf16 v125, v25, s77, v125
    v_dot2_f32_bf16 v126, v29, s77, v126
    v_lshlrev_b32 v93, 16, v36
    v_lshlrev_b32 v94, 16, v40
    v_dot2_f32_bf16 v95, v16, s51, v95
    v_dot2_f32_bf16 v96, v20, s51, v96
    v_dot2_f32_bf16 v115, v21, s54, v115
    v_dot2_f32_bf16 v116, v25, s54, v116
    v_and_b32 v103, 0xffff0000, v36
    v_and_b32 v104, 0xffff0000, v40
    v_dot2_f32_bf16 v105, v16, s71, v105
    v_dot2_f32_bf16 v106, v20, s71, v106
    v_dot2_f32_bf16 v125, v21, s78, v125
    v_dot2_f32_bf16 v126, v25, s78, v126
    v_mul_f32 v95, v95, v93
    v_mul_f32 v96, v96, v94
    v_lshlrev_b32 v113, 16, v37
    v_lshlrev_b32 v114, 16, v41
    v_dot2_f32_bf16 v115, v17, s55, v115
    v_dot2_f32_bf16 v116, v21, s55, v116
    v_mul_f32 v105, v105, v103
    v_mul_f32 v106, v106, v104
    v_and_b32 v123, 0xffff0000, v37
    v_and_b32 v124, 0xffff0000, v41
    v_dot2_f32_bf16 v125, v17, s79, v125
    v_dot2_f32_bf16 v126, v21, s79, v126
    v_cvt_pk_bf16_f32 v97, v96, v95
    v_mul_f32 v115, v115, v113
    v_mul_f32 v116, v116, v114
    v_cvt_pk_bf16_f32 v107, v106, v105
    ds_write_b32 v4, v97 offset:0
    v_mul_f32 v125, v125, v123
    v_mul_f32 v126, v126, v124
    ds_write_b32 v4, v97 offset:4644
    v_cvt_pk_bf16_f32 v117, v116, v115
    ds_write_b32 v4, v107 offset:20416
    v_cvt_pk_bf16_f32 v127, v126, v125
    ds_write_b32 v4, v107 offset:25060
    ds_write_b32 v4, v117 offset:40832
    ds_write_b32 v4, v117 offset:45476
    ds_write_b32 v5, v127 offset:0
    ds_write_b32 v5, v127 offset:4644
    v_dot2_f32_bf16 v95, v30, s56, 0
    v_dot2_f32_bf16 v96, v34, s56, 0
    v_dot2_f32_bf16 v105, v30, s84, 0
    v_dot2_f32_bf16 v106, v34, s84, 0
    v_dot2_f32_bf16 v95, v26, s57, v95
    v_dot2_f32_bf16 v96, v30, s57, v96
    v_dot2_f32_bf16 v115, v31, s60, 0
    v_dot2_f32_bf16 v116, v35, s60, 0
    v_dot2_f32_bf16 v105, v26, s85, v105
    v_dot2_f32_bf16 v106, v30, s85, v106
    v_dot2_f32_bf16 v125, v31, s92, 0
    v_dot2_f32_bf16 v126, v35, s92, 0
    v_dot2_f32_bf16 v95, v22, s58, v95
    v_dot2_f32_bf16 v96, v26, s58, v96
    v_dot2_f32_bf16 v115, v27, s61, v115
    v_dot2_f32_bf16 v116, v31, s61, v116
    v_dot2_f32_bf16 v105, v22, s86, v105
    v_dot2_f32_bf16 v106, v26, s86, v106
    v_dot2_f32_bf16 v125, v27, s93, v125
    v_dot2_f32_bf16 v126, v31, s93, v126
    v_lshlrev_b32 v93, 16, v38
    v_lshlrev_b32 v94, 16, v42
    v_dot2_f32_bf16 v95, v18, s59, v95
    v_dot2_f32_bf16 v96, v22, s59, v96
    v_dot2_f32_bf16 v115, v23, s62, v115
    v_dot2_f32_bf16 v116, v27, s62, v116
    v_and_b32 v103, 0xffff0000, v38
    v_and_b32 v104, 0xffff0000, v42
    v_dot2_f32_bf16 v105, v18, s87, v105
    v_dot2_f32_bf16 v106, v22, s87, v106
    v_dot2_f32_bf16 v125, v23, s94, v125
    v_dot2_f32_bf16 v126, v27, s94, v126
    v_mul_f32 v95, v95, v93
    v_mul_f32 v96, v96, v94
    v_lshlrev_b32 v113, 16, v39
    v_lshlrev_b32 v114, 16, v43
    v_dot2_f32_bf16 v115, v19, s63, v115
    v_dot2_f32_bf16 v116, v23, s63, v116
    v_mul_f32 v105, v105, v103
    v_mul_f32 v106, v106, v104
    v_and_b32 v123, 0xffff0000, v39
    v_and_b32 v124, 0xffff0000, v43
    v_dot2_f32_bf16 v125, v19, s95, v125
    v_dot2_f32_bf16 v126, v23, s95, v126
    v_cvt_pk_bf16_f32 v97, v96, v95
    v_mul_f32 v115, v115, v113
    v_mul_f32 v116, v116, v114
    v_cvt_pk_bf16_f32 v107, v106, v105
    ds_write_b32 v5, v97 offset:20416
    v_mul_f32 v125, v125, v123
    v_mul_f32 v126, v126, v124
    ds_write_b32 v5, v97 offset:25060
    v_cvt_pk_bf16_f32 v117, v116, v115
    ds_write_b32 v5, v107 offset:40832
    v_cvt_pk_bf16_f32 v127, v126, v125
    ds_write_b32 v5, v107 offset:45476
    ds_write_b32 v6, v117 offset:0
    ds_write_b32 v6, v117 offset:4644
    ds_write_b32 v6, v127 offset:20416
    ds_write_b32 v6, v127 offset:25060
    s_mov_b64 exec, 1
    ds_add_u32 v9, v8 offset:0
    s_mov_b64 exec, -1
    v_add_u32 v9, 4, v9
    v_subrev_u32 v4, 1024, v4
    v_subrev_u32 v5, 1024, v5
    v_subrev_u32 v6, 1024, v6
    s_mov_b32 s57, 100000
    s_branch L_h_even2
L_hstage:
    s_mov_b64 exec, 1
    global_load_dwordx4 v[16:19], v3, s[10:11] offset:-3840
    global_load_dwordx4 v[20:23], v3, s[10:11] offset:-2560
    global_load_dwordx4 v[24:27], v3, s[10:11] offset:-1280
    s_mov_b64 exec, -1
    global_load_dwordx4 v[28:31], v3, s[10:11] offset:0
    global_load_dwordx4 v[36:39], v3, s[12:13] offset:0
    global_load_dwordx4 v[32:35], v3, s[10:11] offset:1280
    global_load_dwordx4 v[40:43], v3, s[12:13] offset:1280
    v_add_u32 v3, 655360, v3
    s_mov_b64 exec, 1
    global_load_dwordx4 v[44:47], v3, s[10:11] offset:-3840
    global_load_dwordx4 v[48:51], v3, s[10:11] offset:-2560
    global_load_dwordx4 v[52:55], v3, s[10:11] offset:-1280
    s_mov_b64 exec, -1
    global_load_dwordx4 v[56:59], v3, s[10:11] offset:0
    global_load_dwordx4 v[64:67], v3, s[12:13] offset:0
    global_load_dwordx4 v[60:63], v3, s[10:11] offset:1280
    global_load_dwordx4 v[68:71], v3, s[12:13] offset:1280
    v_add_u32 v3, 655360, v3
    s_waitcnt vmcnt(7)
    s_nop 0
L_h_even:
    v_mov_b32_dpp v20, v28 wave_shr:1 row_mask:0xf bank_mask:0xf
    v_mov_b32_dpp v21, v29 wave_shr:1 row_mask:0xf bank_mask:0xf
    v_mov_b32_dpp v22, v30 wave_shr:1 row_mask:0xf bank_mask:0xf
    v_mov_b32_dpp v23, v31 wave_shr:1 row_mask:0xf bank_mask:0xf
    v_mov_b32_dpp v24, v32 wave_shr:1 row_mask:0xf bank_mask:0xf
    v_mov_b32_dpp v25, v33 wave_shr:1 row_mask:0xf bank_mask:0xf
    v_mov_b32_dpp v26, v34 wave_shr:1 row_mask:0xf bank_mask:0xf
    v_mov_b32_dpp v27, v35 wave_shr:1 row_mask:0xf bank_mask:0xf
    v_mov_b32_dpp v16, v24 wave_shr:1 row_mask:0xf bank_mask:0xf
    v_mov_b32_dpp v17, v25 wave_shr:1 row_mask:0xf bank_mask:0xf
    v_mov_b32_dpp v18, v26 wave_shr:1 row_mask:0xf bank_mask:0xf
    v_mov_b32_dpp v19, v27 wave_shr:1 row_mask:0xf bank_mask:0xf
    v_lshlrev_b32 v88, 16, v16
    v_lshlrev_b32 v89, 16, v20
    v_lshlrev_b32 v90, 16, v24
    v_mul_f32 v95, s67, v88
    v_mul_f32 v96, s67, v89
    v_and_b32 v98, 0xffff0000, v16
    v_and_b32 v99, 0xffff0000, v20
    v_lshlrev_b32 v91, 16, v28
    v_fmac_f32 v95, s66, v89
    v_fmac_f32 v96, s66, v90
    v_and_b32 v100, 0xffff0000, v24
    v_mul_f32 v105, s71, v98
    v_mul_f32 v106, s71, v99
    v_lshlrev_b32 v92, 16, v32
    v_fmac_f32 v95, s65, v90
    v_fmac_f32 v96, s65, v91
    v_and_b32 v101, 0xffff0000, v28
    v_fmac_f32 v105, s70, v99
    v_fmac_f32 v106, s70, v100
    v_lshlrev_b32 v93, 16, v36
    v_lshlrev_b32 v94, 16, v40
    v_fmac_f32 v95, s64, v91
    v_fmac_f32 v96, s64, v92
    v_and_b32 v102, 0xffff0000, v32
    v_fmac_f32 v105, s69, v100
    v_fmac_f32 v106, s69, v101
    v_mul_f32 v95, v95, v93
    v_mul_f32 v96, v96, v94
    v_and_b32 v103, 0xffff0000, v36
    v_and_b32 v104, 0xffff0000, v40
    v_fmac_f32 v105, s68, v101
    v_fmac_f32 v106, s68, v102
    v_cvt_pk_bf16_f32 v97, v96, v95
    v_mul_f32 v105, v105, v103
    v_mul_f32 v106, v106, v104
    ds_write_b32 v4, v97 offset:0
    v_cvt_pk_bf16_f32 v107, v106, v105
    ds_write_b32 v4, v97 offset:4644
    ds_write_b32 v4, v107 offset:20416
    ds_write_b32 v4, v107 offset:25060
    v_lshlrev_b32 v108, 16, v17
    v_lshlrev_b32 v109, 16, v21
    v_lshlrev_b32 v110, 16, v25
    v_mul_f32 v115, s75, v108
    v_mul_f32 v116, s75, v109
    v_and_b32 v118, 0xffff0000, v17
    v_and_b32 v119, 0xffff0000, v21
    v_lshlrev_b32 v111, 16, v29
    v_fmac_f32 v115, s74, v109
    v_fmac_f32 v116, s74, v110
    v_and_b32 v120, 0xffff0000, v25
    v_mul_f32 v125, s79, v118
    v_mul_f32 v126, s79, v119
    v_lshlrev_b32 v112, 16, v33
    v_fmac_f32 v115, s73, v110
    v_fmac_f32 v116, s73, v111
    v_and_b32 v121, 0xffff0000, v29
    v_fmac_f32 v125, s78, v119
    v_fmac_f32 v126, s78, v120
    v_lshlrev_b32 v113, 16, v37
    v_lshlrev_b32 v114, 16, v41
    v_fmac_f32 v115, s72, v111
    v_fmac_f32 v116, s72, v112
    v_and_b32 v122, 0xffff0000, v33
    v_fmac_f32 v125, s77, v120
    v_fmac_f32 v126, s77, v121
    v_mul_f32 v115, v115, v113
    v_mul_f32 v116, v116, v114
    v_and_b32 v123, 0xffff0000, v37
    v_and_b32 v124, 0xffff0000, v41
    v_fmac_f32 v125, s76, v121
    v_fmac_f32 v126, s76, v122
    v_cvt_pk_bf16_f32 v117, v116, v115
    v_mul_f32 v125, v125, v123
    v_mul_f32 v126, v126, v124
    ds_write_b32 v4, v117 offset:40832
    v_cvt_pk_bf16_f32 v127, v126, v125
    ds_write_b32 v4, v117 offset:45476
    ds_write_b32 v5, v127 offset:0
    ds_write_b32 v5, v127 offset:4644
    v_lshlrev_b32 v88, 16, v18
    v_lshlrev_b32 v89, 16, v22
    v_lshlrev_b32 v90, 16, v26
    v_mul_f32 v95, s83, v88
    v_mul_f32 v96, s83, v89
    v_and_b32 v98, 0xffff0000, v18
    v_and_b32 v99, 0xffff0000, v22
    v_lshlrev_b32 v91, 16, v30
    v_fmac_f32 v95, s82, v89
    v_fmac_f32 v96, s82, v90
    v_and_b32 v100, 0xffff0000, v26
    v_mul_f32 v105, s87, v98
    v_mul_f32 v106, s87, v99
    v_lshlrev_b32 v92, 16, v34
    v_fmac_f32 v95, s81, v90
    v_fmac_f32 v96, s81, v91
    v_and_b32 v101, 0xffff0000, v30
    v_fmac_f32 v105, s86, v99
    v_fmac_f32 v106, s86, v100
    v_lshlrev_b32 v93, 16, v38
    v_lshlrev_b32 v94, 16, v42
    v_fmac_f32 v95, s80, v91
    v_fmac_f32 v96, s80, v92
    v_and_b32 v102, 0xffff0000, v34
    v_fmac_f32 v105, s85, v100
    v_fmac_f32 v106, s85, v101
    v_mul_f32 v95, v95, v93
    v_mul_f32 v96, v96, v94
    v_and_b32 v103, 0xffff0000, v38
    v_and_b32 v104, 0xffff0000, v42
    v_fmac_f32 v105, s84, v101
    v_fmac_f32 v106, s84, v102
    v_cvt_pk_bf16_f32 v97, v96, v95
    v_mul_f32 v105, v105, v103
    v_mul_f32 v106, v106, v104
    ds_write_b32 v5, v97 offset:20416
    v_cvt_pk_bf16_f32 v107, v106, v105
    ds_write_b32 v5, v97 offset:25060
    ds_write_b32 v5, v107 offset:40832
    ds_write_b32 v5, v107 offset:45476
    v_lshlrev_b32 v108, 16, v19
    v_lshlrev_b32 v109, 16, v23
    v_lshlrev_b32 v110, 16, v27
    v_mul_f32 v115, s91, v108
    v_mul_f32 v116, s91, v109
    v_and_b32 v118, 0xffff0000, v19
    v_and_b32 v119, 0xffff0000, v23
    v_lshlrev_b32 v111, 16, v31
    v_fmac_f32 v115, s90, v109
    v_fmac_f32 v116, s90, v110
    v_and_b32 v120, 0xffff0000, v27
    v_mul_f32 v125, s95, v118
    v_mul_f32 v126, s95, v119
    v_lshlrev_b32 v112, 16, v35
    v_fmac_f32 v115, s89, v110
    v_fmac_f32 v116, s89, v111
    v_and_b32 v121, 0xffff0000, v31
    v_fmac_f32 v125, s94, v119
    v_fmac_f32 v126, s94, v120
    v_lshlrev_b32 v113, 16, v39
    v_lshlrev_b32 v114, 16, v43
    v_fmac_f32 v115, s88, v111
    v_fmac_f32 v116, s88, v112
    v_and_b32 v122, 0xffff0000, v35
    v_fmac_f32 v125, s93, v120
    v_fmac_f32 v126, s93, v121
    v_mul_f32 v115, v115, v113
    v_mul_f32 v116, v116, v114
    v_and_b32 v123, 0xffff0000, v39
    v_and_b32 v124, 0xffff0000, v43
    v_fmac_f32 v125, s92, v121
    v_fmac_f32 v126, s92, v122
    v_cvt_pk_bf16_f32 v117, v116, v115
    v_mul_f32 v125, v125, v123
    v_mul_f32 v126, v126, v124
    ds_write_b32 v6, v117 offset:0
    v_cvt_pk_bf16_f32 v127, v126, v125
    ds_write_b32 v6, v117 offset:4644
    ds_write_b32 v6, v127 offset:20416
    ds_write_b32 v6, v127 offset:25060
    s_mov_b64 exec, 1
    ds_add_u32 v9, v8 offset:0
    s_mov_b64 exec, -1
    v_add_u32 v9, 4, v9
    v_subrev_u32 v4, 1024, v4
    v_subrev_u32 v5, 1024, v5
    v_subrev_u32 v6, 1024, v6
    s_nop 1
L_h_even2:
    s_cmp_eq_u32 s47, 0
    s_cbranch_scc0 L_h_last
    s_mov_b64 exec, 1
    global_load_dwordx4 v[44:47], v3, s[10:11] offset:-3840
    global_load_dwordx4 v[48:51], v3, s[10:11] offset:-2560
    global_load_dwordx4 v[52:55], v3, s[10:11] offset:-1280
    s_mov_b64 exec, -1
    global_load_dwordx4 v[56:59], v3, s[10:11] offset:0
    global_load_dwordx4 v[64:67], v3, s[12:13] offset:0
    global_load_dwordx4 v[60:63], v3, s[10:11] offset:1280
    global_load_dwordx4 v[68:71], v3, s[12:13] offset:1280
    v_add_u32 v3, 655360, v3
    s_waitcnt vmcnt(0)
    s_branch L_h_odd
L_h_last:
    v_add_u32 v11, 327680, v15
    global_load_dwordx4 v[72:75], v15, s[8:9]
    global_load_dwordx4 v[76:79], v11, s[8:9]
    v_add_u32 v15, 655360, v15
    v_add_u32 v11, 327680, v15
    global_load_dwordx4 v[128:131], v15, s[8:9]
    global_load_dwordx4 v[132:135], v11, s[8:9]
    v_add_u32 v15, 655360, v15
    s_waitcnt vmcnt(4)
    s_nop 0
L_h_odd:
    v_mov_b32_dpp v48, v56 wave_shr:1 row_mask:0xf bank_mask:0xf
    v_mov_b32_dpp v49, v57 wave_shr:1 row_mask:0xf bank_mask:0xf
    v_mov_b32_dpp v50, v58 wave_shr:1 row_mask:0xf bank_mask:0xf
    v_mov_b32_dpp v51, v59 wave_shr:1 row_mask:0xf bank_mask:0xf
    v_mov_b32_dpp v52, v60 wave_shr:1 row_mask:0xf bank_mask:0xf
    v_mov_b32_dpp v53, v61 wave_shr:1 row_mask:0xf bank_mask:0xf
    v_mov_b32_dpp v54, v62 wave_shr:1 row_mask:0xf bank_mask:0xf
    v_mov_b32_dpp v55, v63 wave_shr:1 row_mask:0xf bank_mask:0xf
    v_mov_b32_dpp v44, v52 wave_shr:1 row_mask:0xf bank_mask:0xf
    v_mov_b32_dpp v45, v53 wave_shr:1 row_mask:0xf bank_mask:0xf
    v_mov_b32_dpp v46, v54 wave_shr:1 row_mask:0xf bank_mask:0xf
    v_mov_b32_dpp v47, v55 wave_shr:1 row_mask:0xf bank_mask:0xf
    v_lshlrev_b32 v88, 16, v44
    v_lshlrev_b32 v89, 16, v48
    v_lshlrev_b32 v90, 16, v52
    v_mul_f32 v95, s67, v88
    v_mul_f32 v96, s67, v89
    v_and_b32 v98, 0xffff0000, v44
    v_and_b32 v99, 0xffff0000, v48
    v_lshlrev_b32 v91, 16, v56
    v_fmac_f32 v95, s66, v89
    v_fmac_f32 v96, s66, v90
    v_and_b32 v100, 0xffff0000, v52
    v_mul_f32 v105, s71, v98
    v_mul_f32 v106, s71, v99
    v_lshlrev_b32 v92, 16, v60
    v_fmac_f32 v95, s65, v90
    v_fmac_f32 v96, s65, v91
    v_and_b32 v101, 0xffff0000, v56
    v_fmac_f32 v105, s70, v99
    v_fmac_f32 v106, s70, v100
    v_lshlrev_b32 v93, 16, v64
    v_lshlrev_b32 v94, 16, v68
    v_fmac_f32 v95, s64, v91
    v_fmac_f32 v96, s64, v92
    v_and_b32 v102, 0xffff0000, v60
    v_fmac_f32 v105, s69, v100
    v_fmac_f32 v106, s69, v101
    v_mul_f32 v95, v95, v93
    v_mul_f32 v96, v96, v94
    v_and_b32 v103, 0xffff0000, v64
    v_and_b32 v104, 0xffff0000, v68
    v_fmac_f32 v105, s68, v101
    v_fmac_f32 v106, s68, v102
    v_cvt_pk_bf16_f32 v97, v96, v95
    v_mul_f32 v105, v105, v103
    v_mul_f32 v106, v106, v104
    ds_write_b32 v4, v97 offset:0
    v_cvt_pk_bf16_f32 v107, v106, v105
    ds_write_b32 v4, v97 offset:4644
    ds_write_b32 v4, v107 offset:20416
    ds_write_b32 v4, v107 offset:25060
    v_lshlrev_b32 v108, 16, v45
    v_lshlrev_b32 v109, 16, v49
    v_lshlrev_b32 v110, 16, v53
    v_mul_f32 v115, s75, v108
    v_mul_f32 v116, s75, v109
    v_and_b32 v118, 0xffff0000, v45
    v_and_b32 v119, 0xffff0000, v49
    v_lshlrev_b32 v111, 16, v57
    v_fmac_f32 v115, s74, v109
    v_fmac_f32 v116, s74, v110
    v_and_b32 v120, 0xffff0000, v53
    v_mul_f32 v125, s79, v118
    v_mul_f32 v126, s79, v119
    v_lshlrev_b32 v112, 16, v61
    v_fmac_f32 v115, s73, v110
    v_fmac_f32 v116, s73, v111
    v_and_b32 v121, 0xffff0000, v57
    v_fmac_f32 v125, s78, v119
    v_fmac_f32 v126, s78, v120
    v_lshlrev_b32 v113, 16, v65
    v_lshlrev_b32 v114, 16, v69
    v_fmac_f32 v115, s72, v111
    v_fmac_f32 v116, s72, v112
    v_and_b32 v122, 0xffff0000, v61
    v_fmac_f32 v125, s77, v120
    v_fmac_f32 v126, s77, v121
    v_mul_f32 v115, v115, v113
    v_mul_f32 v116, v116, v114
    v_and_b32 v123, 0xffff0000, v65
    v_and_b32 v124, 0xffff0000, v69
    v_fmac_f32 v125, s76, v121
    v_fmac_f32 v126, s76, v122
    v_cvt_pk_bf16_f32 v117, v116, v115
    v_mul_f32 v125, v125, v123
    v_mul_f32 v126, v126, v124
    ds_write_b32 v4, v117 offset:40832
    v_cvt_pk_bf16_f32 v127, v126, v125
    ds_write_b32 v4, v117 offset:45476
    ds_write_b32 v5, v127 offset:0
    ds_write_b32 v5, v127 offset:4644
    v_lshlrev_b32 v88, 16, v46
    v_lshlrev_b32 v89, 16, v50
    v_lshlrev_b32 v90, 16, v54
    v_mul_f32 v95, s83, v88
    v_mul_f32 v96, s83, v89
    v_and_b32 v98, 0xffff0000, v46
    v_and_b32 v99, 0xffff0000, v50
    v_lshlrev_b32 v91, 16, v58
    v_fmac_f32 v95, s82, v89
    v_fmac_f32 v96, s82, v90
    v_and_b32 v100, 0xffff0000, v54
    v_mul_f32 v105, s87, v98
    v_mul_f32 v106, s87, v99
    v_lshlrev_b32 v92, 16, v62
    v_fmac_f32 v95, s81, v90
    v_fmac_f32 v96, s81, v91
    v_and_b32 v101, 0xffff0000, v58
    v_fmac_f32 v105, s86, v99
    v_fmac_f32 v106, s86, v100
    v_lshlrev_b32 v93, 16, v66
    v_lshlrev_b32 v94, 16, v70
    v_fmac_f32 v95, s80, v91
    v_fmac_f32 v96, s80, v92
    v_and_b32 v102, 0xffff0000, v62
    v_fmac_f32 v105, s85, v100
    v_fmac_f32 v106, s85, v101
    v_mul_f32 v95, v95, v93
    v_mul_f32 v96, v96, v94
    v_and_b32 v103, 0xffff0000, v66
    v_and_b32 v104, 0xffff0000, v70
    v_fmac_f32 v105, s84, v101
    v_fmac_f32 v106, s84, v102
    v_cvt_pk_bf16_f32 v97, v96, v95
    v_mul_f32 v105, v105, v103
    v_mul_f32 v106, v106, v104
    ds_write_b32 v5, v97 offset:20416
    v_cvt_pk_bf16_f32 v107, v106, v105
    ds_write_b32 v5, v97 offset:25060
    ds_write_b32 v5, v107 offset:40832
    ds_write_b32 v5, v107 offset:45476
    v_lshlrev_b32 v108, 16, v47
    v_lshlrev_b32 v109, 16, v51
    v_lshlrev_b32 v110, 16, v55
    v_mul_f32 v115, s91, v108
    v_mul_f32 v116, s91, v109
    v_and_b32 v118, 0xffff0000, v47
    v_and_b32 v119, 0xffff0000, v51
    v_lshlrev_b32 v111, 16, v59
    v_fmac_f32 v115, s90, v109
    v_fmac_f32 v116, s90, v110
    v_and_b32 v120, 0xffff0000, v55
    v_mul_f32 v125, s95, v118
    v_mul_f32 v126, s95, v119
    v_lshlrev_b32 v112, 16, v63
    v_fmac_f32 v115, s89, v110
    v_fmac_f32 v116, s89, v111
    v_and_b32 v121, 0xffff0000, v59
    v_fmac_f32 v125, s94, v119
    v_fmac_f32 v126, s94, v120
    v_lshlrev_b32 v113, 16, v67
    v_lshlrev_b32 v114, 16, v71
    v_fmac_f32 v115, s88, v111
    v_fmac_f32 v116, s88, v112
    v_and_b32 v122, 0xffff0000, v63
    v_fmac_f32 v125, s93, v120
    v_fmac_f32 v126, s93, v121
    v_mul_f32 v115, v115, v113
    v_mul_f32 v116, v116, v114
    v_and_b32 v123, 0xffff0000, v67
    v_and_b32 v124, 0xffff0000, v71
    v_fmac_f32 v125, s92, v121
    v_fmac_f32 v126, s92, v122
    v_cvt_pk_bf16_f32 v117, v116, v115
    v_mul_f32 v125, v125, v123
    v_mul_f32 v126, v126, v124
    ds_write_b32 v6, v117 offset:0
    v_cvt_pk_bf16_f32 v127, v126, v125
    ds_write_b32 v6, v117 offset:4644
    ds_write_b32 v6, v127 offset:20416
    ds_write_b32 v6, v127 offset:25060
    s_mov_b64 exec, 1
    ds_add_u32 v9, v8 offset:0
    s_mov_b64 exec, -1
    v_add_u32 v9, 4, v9
    v_subrev_u32 v4, 1024, v4
    v_subrev_u32 v5, 1024, v5
    v_subrev_u32 v6, 1024, v6
    s_add_u32 s47, s47, 2
    s_cmp_lt_u32 s47, 4
    s_cbranch_scc1 L_hstage
    s_waitcnt vmcnt(2)
    v_lshlrev_b32 v90, 16, v72
    v_and_b32 v91, 0xffff0000, v72
    v_lshlrev_b32 v94, 16, v73
    v_and_b32 v95, 0xffff0000, v73
    v_lshlrev_b32 v98, 16, v74
    v_and_b32 v99, 0xffff0000, v74
    v_lshlrev_b32 v102, 16, v75
    v_and_b32 v103, 0xffff0000, v75
    v_lshlrev_b32 v106, 16, v76
    v_and_b32 v107, 0xffff0000, v76
    v_lshlrev_b32 v110, 16, v77
    v_and_b32 v111, 0xffff0000, v77
    v_lshlrev_b32 v114, 16, v78
    v_and_b32 v115, 0xffff0000, v78
    v_lshlrev_b32 v118, 16, v79
    v_and_b32 v119, 0xffff0000, v79
L_spin9:
    ds_read_b32 v10, v7 offset:16
    s_waitcnt lgkmcnt(0)
    v_readfirstlane_b32 s7, v10
    s_nop 0
    s_cmp_ge_u32 s7, 8
    s_cbranch_scc1 L_spun9
    s_sleep 1
    s_sub_u32 s57, s57, 1
    s_cbranch_scc0 L_spin9
    s_mov_b32 s57, 0
L_spun9:
    ds_read_b64_tr_b16 v[80:81], v12 offset:3072
    ds_read_b64_tr_b16 v[82:83], v13 offset:3072
    s_waitcnt lgkmcnt(0)
    v_lshlrev_b32 v88, 16, v80
    v_and_b32 v89, 0xffff0000, v80
    v_lshlrev_b32 v92, 16, v81
    v_and_b32 v93, 0xffff0000, v81
    v_lshlrev_b32 v96, 16, v82
    v_and_b32 v97, 0xffff0000, v82
    v_lshlrev_b32 v100, 16, v83
    v_and_b32 v101, 0xffff0000, v83
    v_mul_f32 v88, v88, v90
    v_mul_f32 v89, v89, v91
    v_mul_f32 v92, v92, v94
    v_mul_f32 v93, v93, v95
    v_mul_f32 v96, v96, v98
    v_mul_f32 v97, v97, v99
    v_mul_f32 v100, v100, v102
    v_mul_f32 v101, v101, v103
    v_cvt_pk_bf16_f32 v80, v88, v89
    v_cvt_pk_bf16_f32 v81, v92, v93
    v_cvt_pk_bf16_f32 v82, v96, v97
    v_cvt_pk_bf16_f32 v83, v100, v101
    global_store_dwordx4 v14, v[80:83], s[38:39]
    s_nop 1
    v_add_u32 v14, 655360, v14
L_spin10:
    ds_read_b32 v10, v7 offset:20
    s_waitcnt lgkmcnt(0)
    v_readfirstlane_b32 s7, v10
    s_nop 0
    s_cmp_ge_u32 s7, 8
    s_cbranch_scc1 L_spun10
    s_sleep 1
    s_sub_u32 s57, s57, 1
    s_cbranch_scc0 L_spin10
    s_mov_b32 s57, 0
L_spun10:
    ds_read_b64_tr_b16 v[84:85], v12 offset:7296
    ds_read_b64_tr_b16 v[86:87], v13 offset:7296
    s_waitcnt lgkmcnt(0)
    v_lshlrev_b32 v104, 16, v84
    v_and_b32 v105, 0xffff0000, v84
    v_lshlrev_b32 v108, 16, v85
    v_and_b32 v109, 0xffff0000, v85
    v_lshlrev_b32 v112, 16, v86
    v_and_b32 v113, 0xffff0000, v86
    v_lshlrev_b32 v116, 16, v87
    v_and_b32 v117, 0xffff0000, v87
    v_mul_f32 v104, v104, v106
    v_mul_f32 v105, v105, v107
    v_mul_f32 v108, v108, v110
    v_mul_f32 v109, v109, v111
    v_mul_f32 v112, v112, v114
    v_mul_f32 v113, v113, v115
    v_mul_f32 v116, v116, v118
    v_mul_f32 v117, v117, v119
    v_cvt_pk_bf16_f32 v84, v104, v105
    v_cvt_pk_bf16_f32 v85, v108, v109
    v_cvt_pk_bf16_f32 v86, v112, v113
    v_cvt_pk_bf16_f32 v87, v116, v117
    global_store_dwordx4 v14, v[84:87], s[38:39]
    s_nop 1
    v_add_u32 v14, 655360, v14
    v_add_u32 v11, 327680, v15
    global_load_dwordx4 v[136:139], v15, s[8:9]
    global_load_dwordx4 v[140:143], v11, s[8:9]
    v_add_u32 v15, 655360, v15
    v_add_u32 v11, 327680, v15
    global_load_dwordx4 v[144:147], v15, s[8:9]
    global_load_dwordx4 v[148:151], v11, s[8:9]
    v_add_u32 v15, 655360, v15
    s_waitcnt vmcnt(6)
    v_lshlrev_b32 v90, 16, v128
    v_and_b32 v91, 0xffff0000, v128
    v_lshlrev_b32 v94, 16, v129
    v_and_b32 v95, 0xffff0000, v129
    v_lshlrev_b32 v98, 16, v130
    v_and_b32 v99, 0xffff0000, v130
    v_lshlrev_b32 v102, 16, v131
    v_and_b32 v103, 0xffff0000, v131
    v_lshlrev_b32 v106, 16, v132
    v_and_b32 v107, 0xffff0000, v132
    v_lshlrev_b32 v110, 16, v133
    v_and_b32 v111, 0xffff0000, v133
    v_lshlrev_b32 v114, 16, v134
    v_and_b32 v115, 0xffff0000, v134
    v_lshlrev_b32 v118, 16, v135
    v_and_b32 v119, 0xffff0000, v135
L_spin11:
    ds_read_b32 v10, v7 offset:24
    s_waitcnt lgkmcnt(0)
    v_readfirstlane_b32 s7, v10
    s_nop 0
    s_cmp_ge_u32 s7, 8
    s_cbranch_scc1 L_spun11
    s_sleep 1
    s_sub_u32 s57, s57, 1
    s_cbranch_scc0 L_spin11
    s_mov_b32 s57, 0
L_spun11:
    ds_read_b64_tr_b16 v[16:17], v12 offset:2048
    ds_read_b64_tr_b16 v[18:19], v13 offset:2048
    s_waitcnt lgkmcnt(0)
    v_lshlrev_b32 v88, 16, v16
    v_and_b32 v89, 0xffff0000, v16
    v_lshlrev_b32 v92, 16, v17
    v_and_b32 v93, 0xffff0000, v17
    v_lshlrev_b32 v96, 16, v18
    v_and_b32 v97, 0xffff0000, v18
    v_lshlrev_b32 v100, 16, v19
    v_and_b32 v101, 0xffff0000, v19
    v_mul_f32 v88, v88, v90
    v_mul_f32 v89, v89, v91
    v_mul_f32 v92, v92, v94
    v_mul_f32 v93, v93, v95
    v_mul_f32 v96, v96, v98
    v_mul_f32 v97, v97, v99
    v_mul_f32 v100, v100, v102
    v_mul_f32 v101, v101, v103
    v_cvt_pk_bf16_f32 v16, v88, v89
    v_cvt_pk_bf16_f32 v17, v92, v93
    v_cvt_pk_bf16_f32 v18, v96, v97
    v_cvt_pk_bf16_f32 v19, v100, v101
    global_store_dwordx4 v14, v[16:19], s[38:39]
    s_nop 1
    v_add_u32 v14, 655360, v14
L_spin12:
    ds_read_b32 v10, v7 offset:28
    s_waitcnt lgkmcnt(0)
    v_readfirstlane_b32 s7, v10
    s_nop 0
    s_cmp_ge_u32 s7, 8
    s_cbranch_scc1 L_spun12
    s_sleep 1
    s_sub_u32 s57, s57, 1
    s_cbranch_scc0 L_spin12
    s_mov_b32 s57, 0
L_spun12:
    ds_read_b64_tr_b16 v[20:21], v12 offset:6272
    ds_read_b64_tr_b16 v[22:23], v13 offset:6272
    s_waitcnt lgkmcnt(0)
    v_lshlrev_b32 v104, 16, v20
    v_and_b32 v105, 0xffff0000, v20
    v_lshlrev_b32 v108, 16, v21
    v_and_b32 v109, 0xffff0000, v21
    v_lshlrev_b32 v112, 16, v22
    v_and_b32 v113, 0xffff0000, v22
    v_lshlrev_b32 v116, 16, v23
    v_and_b32 v117, 0xffff0000, v23
    v_mul_f32 v104, v104, v106
    v_mul_f32 v105, v105, v107
    v_mul_f32 v108, v108, v110
    v_mul_f32 v109, v109, v111
    v_mul_f32 v112, v112, v114
    v_mul_f32 v113, v113, v115
    v_mul_f32 v116, v116, v118
    v_mul_f32 v117, v117, v119
    v_cvt_pk_bf16_f32 v20, v104, v105
    v_cvt_pk_bf16_f32 v21, v108, v109
    v_cvt_pk_bf16_f32 v22, v112, v113
    v_cvt_pk_bf16_f32 v23, v116, v117
    global_store_dwordx4 v14, v[20:23], s[38:39]
    s_nop 1
    v_add_u32 v14, 655360, v14
    s_waitcnt vmcnt(4)
    v_lshlrev_b32 v90, 16, v136
    v_and_b32 v91, 0xffff0000, v136
    v_lshlrev_b32 v94, 16, v137
    v_and_b32 v95, 0xffff0000, v137
    v_lshlrev_b32 v98, 16, v138
    v_and_b32 v99, 0xffff0000, v138
    v_lshlrev_b32 v102, 16, v139
    v_and_b32 v103, 0xffff0000, v139
    v_lshlrev_b32 v106, 16, v140
    v_and_b32 v107, 0xffff0000, v140
    v_lshlrev_b32 v110, 16, v141
    v_and_b32 v111, 0xffff0000, v141
    v_lshlrev_b32 v114, 16, v142
    v_and_b32 v115, 0xffff0000, v142
    v_lshlrev_b32 v118, 16, v143
    v_and_b32 v119, 0xffff0000, v143
L_spin13:
    ds_read_b32 v10, v7 offset:32
    s_waitcnt lgkmcnt(0)
    v_readfirstlane_b32 s7, v10
    s_nop 0
    s_cmp_ge_u32 s7, 8
    s_cbranch_scc1 L_spun13
    s_sleep 1
    s_sub_u32 s57, s57, 1
    s_cbranch_scc0 L_spin13
    s_mov_b32 s57, 0
L_spun13:
    ds_read_b64_tr_b16 v[80:81], v12 offset:1024
    ds_read_b64_tr_b16 v[82:83], v13 offset:1024
    s_waitcnt lgkmcnt(0)
    v_lshlrev_b32 v88, 16, v80
    v_and_b32 v89, 0xffff0000, v80
    v_lshlrev_b32 v92, 16, v81
    v_and_b32 v93, 0xffff0000, v81
    v_lshlrev_b32 v96, 16, v82
    v_and_b32 v97, 0xffff0000, v82
    v_lshlrev_b32 v100, 16, v83
    v_and_b32 v101, 0xffff0000, v83
    v_mul_f32 v88, v88, v90
    v_mul_f32 v89, v89, v91
    v_mul_f32 v92, v92, v94
    v_mul_f32 v93, v93, v95
    v_mul_f32 v96, v96, v98
    v_mul_f32 v97, v97, v99
    v_mul_f32 v100, v100, v102
    v_mul_f32 v101, v101, v103
    v_cvt_pk_bf16_f32 v80, v88, v89
    v_cvt_pk_bf16_f32 v81, v92, v93
    v_cvt_pk_bf16_f32 v82, v96, v97
    v_cvt_pk_bf16_f32 v83, v100, v101
    global_store_dwordx4 v14, v[80:83], s[38:39]
    s_nop 1
    v_add_u32 v14, 655360, v14
L_spin14:
    ds_read_b32 v10, v7 offset:36
    s_waitcnt lgkmcnt(0)
    v_readfirstlane_b32 s7, v10
    s_nop 0
    s_cmp_ge_u32 s7, 8
    s_cbranch_scc1 L_spun14
    s_sleep 1
    s_sub_u32 s57, s57, 1
    s_cbranch_scc0 L_spin14
    s_mov_b32 s57, 0
L_spun14:
    ds_read_b64_tr_b16 v[84:85], v12 offset:5248
    ds_read_b64_tr_b16 v[86:87], v13 offset:5248
    s_waitcnt lgkmcnt(0)
    v_lshlrev_b32 v104, 16, v84
    v_and_b32 v105, 0xffff0000, v84
    v_lshlrev_b32 v108, 16, v85
    v_and_b32 v109, 0xffff0000, v85
    v_lshlrev_b32 v112, 16, v86
    v_and_b32 v113, 0xffff0000, v86
    v_lshlrev_b32 v116, 16, v87
    v_and_b32 v117, 0xffff0000, v87
    v_mul_f32 v104, v104, v106
    v_mul_f32 v105, v105, v107
    v_mul_f32 v108, v108, v110
    v_mul_f32 v109, v109, v111
    v_mul_f32 v112, v112, v114
    v_mul_f32 v113, v113, v115
    v_mul_f32 v116, v116, v118
    v_mul_f32 v117, v117, v119
    v_cvt_pk_bf16_f32 v84, v104, v105
    v_cvt_pk_bf16_f32 v85, v108, v109
    v_cvt_pk_bf16_f32 v86, v112, v113
    v_cvt_pk_bf16_f32 v87, v116, v117
    global_store_dwordx4 v14, v[84:87], s[38:39]
    s_nop 1
    v_add_u32 v14, 655360, v14
    s_waitcnt vmcnt(4)
    v_lshlrev_b32 v90, 16, v144
    v_and_b32 v91, 0xffff0000, v144
    v_lshlrev_b32 v94, 16, v145
    v_and_b32 v95, 0xffff0000, v145
    v_lshlrev_b32 v98, 16, v146
    v_and_b32 v99, 0xffff0000, v146
    v_lshlrev_b32 v102, 16, v147
    v_and_b32 v103, 0xffff0000, v147
    v_lshlrev_b32 v106, 16, v148
    v_and_b32 v107, 0xffff0000, v148
    v_lshlrev_b32 v110, 16, v149
    v_and_b32 v111, 0xffff0000, v149
    v_lshlrev_b32 v114, 16, v150
    v_and_b32 v115, 0xffff0000, v150
    v_lshlrev_b32 v118, 16, v151
    v_and_b32 v119, 0xffff0000, v151
L_spin15:
    ds_read_b32 v10, v7 offset:40
    s_waitcnt lgkmcnt(0)
    v_readfirstlane_b32 s7, v10
    s_nop 0
    s_cmp_ge_u32 s7, 8
    s_cbranch_scc1 L_spun15
    s_sleep 1
    s_sub_u32 s57, s57, 1
    s_cbranch_scc0 L_spin15
    s_mov_b32 s57, 0
L_spun15:
    ds_read_b64_tr_b16 v[16:17], v12 offset:0
    ds_read_b64_tr_b16 v[18:19], v13 offset:0
    s_waitcnt lgkmcnt(0)
    v_lshlrev_b32 v88, 16, v16
    v_and_b32 v89, 0xffff0000, v16
    v_lshlrev_b32 v92, 16, v17
    v_and_b32 v93, 0xffff0000, v17
    v_lshlrev_b32 v96, 16, v18
    v_and_b32 v97, 0xffff0000, v18
    v_lshlrev_b32 v100, 16, v19
    v_and_b32 v101, 0xffff0000, v19
    v_mul_f32 v88, v88, v90
    v_mul_f32 v89, v89, v91
    v_mul_f32 v92, v92, v94
    v_mul_f32 v93, v93, v95
    v_mul_f32 v96, v96, v98
    v_mul_f32 v97, v97, v99
    v_mul_f32 v100, v100, v102
    v_mul_f32 v101, v101, v103
    v_cvt_pk_bf16_f32 v16, v88, v89
    v_cvt_pk_bf16_f32 v17, v92, v93
    v_cvt_pk_bf16_f32 v18, v96, v97
    v_cvt_pk_bf16_f32 v19, v100, v101
    global_store_dwordx4 v14, v[16:19], s[38:39]
    s_nop 1
    v_add_u32 v14, 655360, v14
L_spin16:
    ds_read_b32 v10, v7 offset:44
    s_waitcnt lgkmcnt(0)
    v_readfirstlane_b32 s7, v10
    s_nop 0
    s_cmp_ge_u32 s7, 8
    s_cbranch_scc1 L_spun16
    s_sleep 1
    s_sub_u32 s57, s57, 1
    s_cbranch_scc0 L_spin16
    s_mov_b32 s57, 0
L_spun16:
    ds_read_b64_tr_b16 v[20:21], v12 offset:4224
    ds_read_b64_tr_b16 v[22:23], v13 offset:4224
    s_waitcnt lgkmcnt(0)
    v_lshlrev_b32 v104, 16, v20
    v_and_b32 v105, 0xffff0000, v20
    v_lshlrev_b32 v108, 16, v21
    v_and_b32 v109, 0xffff0000, v21
    v_lshlrev_b32 v112, 16, v22
    v_and_b32 v113, 0xffff0000, v22
    v_lshlrev_b32 v116, 16, v23
    v_and_b32 v117, 0xffff0000, v23
    v_mul_f32 v104, v104, v106
    v_mul_f32 v105, v105, v107
    v_mul_f32 v108, v108, v110
    v_mul_f32 v109, v109, v111
    v_mul_f32 v112, v112, v114
    v_mul_f32 v113, v113, v115
    v_mul_f32 v116, v116, v118
    v_mul_f32 v117, v117, v119
    v_cvt_pk_bf16_f32 v20, v104, v105
    v_cvt_pk_bf16_f32 v21, v108, v109
    v_cvt_pk_bf16_f32 v22, v112, v113
    v_cvt_pk_bf16_f32 v23, v116, v117
    global_store_dwordx4 v14, v[20:23], s[38:39]
    s_nop 1
    v_add_u32 v14, 655360, v14
    s_endpgm
L_wgB2:
    s_barrier
    s_sub_u32 s6, s5, 4
    s_cmp_ge_u32 s6, 2
    s_cbranch_scc1 L_pf17
    s_cmp_ge_u32 s50, 16
    s_cbranch_scc1 L_pf17
    s_lshr_b32 s7, s50, 3
    s_cmp_eq_u32 s7, 1
    s_cselect_b64 s[54:55], s[12:13], s[10:11]
    s_mul_i32 s56, s7, 0
    s_and_b32 s7, s6, 1
    s_mul_i32 s7, s7, 0
    s_add_u32 s56, s56, s7
    s_add_u32 s56, s56, 0
    s_bitcmp1_b32 s6, 0
    s_cselect_b32 s7, s52, s51
    s_cbranch_scc0 L_pfg17
    s_cmp_ge_u32 s4, 4
    s_cbranch_scc1 L_pf17
L_pfg17:
    s_add_u32 s56, s56, s7
    v_add_u32 v25, s56, v24
    global_load_dword v26, v25, s[54:55]
L_pf17:
    s_mul_i32 s53, s5, 9216
    s_add_u32 s53, s53, 81664
    s_add_u32 s6, s44, 9264
    s_cmp_ge_u32 s5, 8
    s_cselect_b32 s53, s6, s53
    s_mov_b32 m0, s53
    v_and_b32 v10, 15, v1
    v_mul_u32_u24 v9, 288, v10
    v_lshrrev_b32 v10, 4, v1
    v_lshl_add_u32 v9, v10, 4, v9
    v_add_u32 v6, s53, v9
    s_waitcnt vmcnt(1)
    s_sub_u32 s6, s5, 0
    s_cmp_ge_u32 s6, 2
    s_cbranch_scc1 L_pf18
    s_cmp_ge_u32 s50, 16
    s_cbranch_scc1 L_pf18
    s_lshr_b32 s7, s50, 3
    s_cmp_eq_u32 s7, 1
    s_cselect_b64 s[54:55], s[12:13], s[10:11]
    s_mul_i32 s56, s7, 0
    s_and_b32 s7, s6, 1
    s_mul_i32 s7, s7, 0
    s_add_u32 s56, s56, s7
    s_add_u32 s56, s56, 655360
    s_bitcmp1_b32 s6, 0
    s_cselect_b32 s7, s52, s51
    s_cbranch_scc0 L_pfg18
    s_cmp_ge_u32 s4, 4
    s_cbranch_scc1 L_pf18
L_pfg18:
    s_add_u32 s56, s56, s7
    v_add_u32 v25, s56, v24
    global_load_dword v26, v25, s[54:55]
L_pf18:
    s_sub_u32 s6, s5, 4
    s_cmp_ge_u32 s6, 4
    s_cbranch_scc1 L_pf19
    s_cmp_ge_u32 s50, 16
    s_cbranch_scc1 L_pf19
    s_lshr_b32 s7, s50, 3
    s_mov_b64 s[54:55], s[20:21]
    s_mul_i32 s56, s7, 1310720
    s_and_b32 s7, s6, 1
    s_mul_i32 s7, s7, 655360
    s_add_u32 s56, s56, s7
    s_add_u32 s56, s56, 0
    s_bitcmp1_b32 s6, 1
    s_cselect_b32 s7, s52, s51
    s_cbranch_scc0 L_pfg19
    s_cmp_ge_u32 s4, 4
    s_cbranch_scc0 L_pf19
L_pfg19:
    s_add_u32 s56, s56, s7
    v_add_u32 v25, s56, v24
    global_load_dword v26, v25, s[54:55]
L_pf19:
    v_mul_f32 v9, 0x3fb8aa3b, v22
    v_exp_f32 v9, v9
    s_nop 0
    v_cvt_pk_bf16_f32 v9, v9, v9
    v_lshlrev_b32 v7, 16, v9
    v_mul_f32 v8, 0x3fb8aa3b, v7
    v_mul_f32 v11, 0.15915494, v7
    v_mul_f32 v139, v11, v17
    v_mul_f32 v138, v8, v16
    v_mul_f32 v132, v20, v18
    v_mul_f32 v143, 0x41000000, v139
    v_mul_f32 v133, v20, v19
    v_mul_f32 v141, 0x43000000, v139
    v_fract_f32 v145, v139
    v_mul_f32 v142, 0x41000000, v138
    v_fract_f32 v143, v143
    v_fma_f32 v132, -v21, v19, v132
    v_fmac_f32 v133, v21, v18
    v_mul_f32 v140, 0x43000000, v138
    v_fract_f32 v141, v141
    v_exp_f32 v144, v138
    v_cos_f32 v122, v145
    v_sin_f32 v123, v145
    v_exp_f32 v142, v142
    v_cos_f32 v134, v143
    v_sin_f32 v135, v143
    v_mul_f32 v132, v7, v132
    v_mul_f32 v133, v7, v133
    v_exp_f32 v140, v140
    v_cos_f32 v128, v141
    v_sin_f32 v129, v141
    v_mul_f32 v122, v144, v122
    v_mul_f32 v123, v144, v123
    v_mul_f32 v134, v142, v134
    v_mul_f32_e64 v135, -v142, v135
    v_mul_f32 v128, v140, v128
    v_mul_f32 v129, v140, v129
    v_pk_mul_f32 v[148:149], v[132:133], v[122:123] op_sel_hi:[0,1]
    v_pk_mul_f32 v[130:131], v[134:135], v[134:135] op_sel_hi:[0,1]
    v_pk_mul_f32 v[146:147], v[132:133], v[128:129] op_sel_hi:[0,1]
    v_pk_fma_f32 v[148:149], v[132:133], v[122:123], v[148:149] op_sel:[1,1,0] op_sel_hi:[1,0,1] neg_lo:[1,0,0]
    v_pk_mul_f32 v[136:137], v[128:129], v[128:129] op_sel_hi:[0,1]
    v_pk_fma_f32 v[130:131], v[134:135], v[134:135], v[130:131] op_sel:[1,1,0] op_sel_hi:[1,0,1] neg_lo:[1,0,0]
    v_pk_fma_f32 v[146:147], v[132:133], v[128:129], v[146:147] op_sel:[1,1,0] op_sel_hi:[1,0,1] neg_lo:[1,0,0]
    v_pk_mul_f32 v[160:161], v[148:149], v[122:123] op_sel_hi:[0,1]
    v_pk_fma_f32 v[136:137], v[128:129], v[128:129], v[136:137] op_sel:[1,1,0] op_sel_hi:[1,0,1] neg_lo:[1,0,0]
    v_pk_mul_f32 v[156:157], v[134:135], v[130:131] op_sel_hi:[0,1]
    v_pk_mul_f32 v[152:153], v[146:147], v[122:123] op_sel_hi:[0,1]
    v_pk_fma_f32 v[160:161], v[148:149], v[122:123], v[160:161] op_sel:[1,1,0] op_sel_hi:[1,0,1] neg_lo:[1,0,0]
    v_pk_mul_f32 v[124:125], v[122:123], v[122:123] op_sel_hi:[0,1]
    v_pk_mul_f32 v[154:155], v[146:147], v[136:137] op_sel_hi:[0,1]
    v_cvt_pk_bf16_f32 v14, v148, v149
    v_pk_mul_f32 v[150:151], v[132:133], v[136:137] op_sel_hi:[0,1]
    v_pk_fma_f32 v[156:157], v[134:135], v[130:131], v[156:157] op_sel:[1,1,0] op_sel_hi:[1,0,1] neg_lo:[1,0,0]
    ds_write_addtid_b32 v14 offset:4896
    v_pk_fma_f32 v[152:153], v[146:147], v[122:123], v[152:153] op_sel:[1,1,0] op_sel_hi:[1,0,1] neg_lo:[1,0,0]
    v_pk_mul_f32 v[148:149], v[160:161], v[122:123] op_sel_hi:[0,1]
    v_pk_fma_f32 v[124:125], v[122:123], v[122:123], v[124:125] op_sel:[1,1,0] op_sel_hi:[1,0,1] neg_lo:[1,0,0]
    v_pk_fma_f32 v[154:155], v[146:147], v[136:137], v[154:155] op_sel:[1,1,0] op_sel_hi:[1,0,1] neg_lo:[1,0,0]
    v_pk_fma_f32 v[150:151], v[132:133], v[136:137], v[150:151] op_sel:[1,1,0] op_sel_hi:[1,0,1] neg_lo:[1,0,0]
    v_pk_mul_f32 v[158:159], v[130:131], v[130:131] op_sel_hi:[0,1]
    v_pk_mul_f32 v[138:139], v[156:157], v[130:131] op_sel_hi:[0,1]
    v_pk_mul_f32 v[162:163], v[152:153], v[122:123] op_sel_hi:[0,1]
    v_pk_fma_f32 v[148:149], v[160:161], v[122:123], v[148:149] op_sel:[1,1,0] op_sel_hi:[1,0,1] neg_lo:[1,0,0]
    v_pk_mul_f32 v[126:127], v[124:125], v[124:125] op_sel_hi:[0,1]
    v_pk_mul_f32 v[144:145], v[154:155], v[136:137] op_sel_hi:[0,1]
    v_cvt_pk_bf16_f32 v5, v156, v157
    v_pk_fma_f32 v[158:159], v[130:131], v[130:131], v[158:159] op_sel:[1,1,0] op_sel_hi:[1,0,1] neg_lo:[1,0,0]
    v_pk_mul_f32 v[164:165], v[150:151], v[124:125] op_sel_hi:[0,1]
    ds_write_addtid_b32 v5 offset:864
    v_pk_fma_f32 v[138:139], v[156:157], v[130:131], v[138:139] op_sel:[1,1,0] op_sel_hi:[1,0,1] neg_lo:[1,0,0]
    v_pk_fma_f32 v[162:163], v[152:153], v[122:123], v[162:163] op_sel:[1,1,0] op_sel_hi:[1,0,1] neg_lo:[1,0,0]
    v_pk_mul_f32 v[156:157], v[148:149], v[122:123] op_sel_hi:[0,1]
    v_pk_fma_f32 v[126:127], v[124:125], v[124:125], v[126:127] op_sel:[1,1,0] op_sel_hi:[1,0,1] neg_lo:[1,0,0]
    v_cvt_pk_bf16_f32 v15, v146, v147
    v_pk_fma_f32 v[144:145], v[154:155], v[136:137], v[144:145] op_sel:[1,1,0] op_sel_hi:[1,0,1] neg_lo:[1,0,0]
    v_cvt_pk_bf16_f32 v9, v152, v153
    ds_write_addtid_b32 v15 offset:6912
    v_pk_fma_f32 v[164:165], v[150:151], v[124:125], v[164:165] op_sel:[1,1,0] op_sel_hi:[1,0,1] neg_lo:[1,0,0]
    v_pk_mul_f32 v[146:147], v[158:159], v[130:131] op_sel_hi:[0,1]
    ds_write_addtid_b32 v9 offset:7200
    v_cvt_pk_bf16_f32 v33, v148, v149
    v_pk_mul_f32 v[152:153], v[162:163], v[122:123] op_sel_hi:[0,1]
    v_pk_fma_f32 v[156:157], v[148:149], v[122:123], v[156:157] op_sel:[1,1,0] op_sel_hi:[1,0,1] neg_lo:[1,0,0]
    ds_write_addtid_b32 v33 offset:5472
    v_cvt_pk_bf16_f32 v29, v160, v161
    v_pk_mul_f32 v[142:143], v[154:155], v[124:125] op_sel_hi:[0,1]
    v_pk_mul_f32 v[148:149], v[144:145], v[126:127] op_sel_hi:[0,1]
    ds_write_addtid_b32 v29 offset:5184
    v_pk_fma_f32 v[146:147], v[158:159], v[130:131], v[146:147] op_sel:[1,1,0] op_sel_hi:[1,0,1] neg_lo:[1,0,0]
    v_pk_mul_f32 v[160:161], v[164:165], v[124:125] op_sel_hi:[0,1]
    v_pk_mul_f32 v[140:141], v[150:151], v[136:137] op_sel_hi:[0,1]
    v_pk_fma_f32 v[152:153], v[162:163], v[122:123], v[152:153] op_sel:[1,1,0] op_sel_hi:[1,0,1] neg_lo:[1,0,0]
    v_cvt_pk_bf16_f32 v100, v154, v155
    v_pk_fma_f32 v[142:143], v[154:155], v[124:125], v[142:143] op_sel:[1,1,0] op_sel_hi:[1,0,1] neg_lo:[1,0,0]
    v_pk_fma_f32 v[148:149], v[144:145], v[126:127], v[148:149] op_sel:[1,1,0] op_sel_hi:[1,0,1] neg_lo:[1,0,0]
    v_cvt_pk_bf16_f32 v28, v158, v159
    v_pk_mul_f32 v[154:155], v[146:147], v[130:131] op_sel_hi:[0,1]
    v_pk_fma_f32 v[160:161], v[164:165], v[124:125], v[160:161] op_sel:[1,1,0] op_sel_hi:[1,0,1] neg_lo:[1,0,0]
    ds_write_addtid_b32 v28 offset:1152
    v_pk_fma_f32 v[140:141], v[150:151], v[136:137], v[140:141] op_sel:[1,1,0] op_sel_hi:[1,0,1] neg_lo:[1,0,0]
    v_pk_mul_f32 v[158:159], v[152:153], v[122:123] op_sel_hi:[0,1]
    v_cvt_pk_bf16_f32 v30, v162, v163
    v_cvt_pk_bf16_f32 v96, v150, v151
    v_cvt_pk_bf16_f32 v107, v148, v149
    ds_write_addtid_b32 v30 offset:7488
    v_cvt_pk_bf16_f32 v32, v146, v147
    v_pk_mul_f32 v[150:151], v[138:139], v[130:131] op_sel_hi:[0,1]
    v_pk_fma_f32 v[154:155], v[146:147], v[130:131], v[154:155] op_sel:[1,1,0] op_sel_hi:[1,0,1] neg_lo:[1,0,0]
    ds_write_addtid_b32 v32 offset:1728
    v_pk_mul_f32 v[162:163], v[142:143], v[124:125] op_sel_hi:[0,1]
    v_pk_mul_f32 v[148:149], v[160:161], v[124:125] op_sel_hi:[0,1]
    v_cvt_pk_bf16_f32 v34, v152, v153
    v_pk_fma_f32 v[158:159], v[152:153], v[122:123], v[158:159] op_sel:[1,1,0] op_sel_hi:[1,0,1] neg_lo:[1,0,0]
    v_pk_mul_f32 v[146:147], v[140:141], v[136:137] op_sel_hi:[0,1]
    ds_write_addtid_b32 v34 offset:7776
    v_pk_mul_f32 v[152:153], v[144:145], v[136:137] op_sel_hi:[0,1]
    v_cvt_pk_bf16_f32 v31, v138, v139
    v_pk_fma_f32 v[150:151], v[138:139], v[130:131], v[150:151] op_sel:[1,1,0] op_sel_hi:[1,0,1] neg_lo:[1,0,0]
    v_pk_fma_f32 v[162:163], v[142:143], v[124:125], v[162:163] op_sel:[1,1,0] op_sel_hi:[1,0,1] neg_lo:[1,0,0]
    ds_write_addtid_b32 v31 offset:1440
    v_pk_fma_f32 v[148:149], v[160:161], v[124:125], v[148:149] op_sel:[1,1,0] op_sel_hi:[1,0,1] neg_lo:[1,0,0]
    v_pk_mul_f32 v[138:139], v[140:141], v[126:127] op_sel_hi:[0,1]
    v_pk_fma_f32 v[146:147], v[140:141], v[136:137], v[146:147] op_sel:[1,1,0] op_sel_hi:[1,0,1] neg_lo:[1,0,0]
    v_cvt_pk_bf16_f32 v106, v144, v145
    v_pk_fma_f32 v[152:153], v[144:145], v[136:137], v[152:153] op_sel:[1,1,0] op_sel_hi:[1,0,1] neg_lo:[1,0,0]
    v_cvt_pk_bf16_f32 v99, v148, v149
    v_pk_mul_f32 v[144:145], v[162:163], v[124:125] op_sel_hi:[0,1]
    v_pk_fma_f32 v[138:139], v[140:141], v[126:127], v[138:139] op_sel:[1,1,0] op_sel_hi:[1,0,1] neg_lo:[1,0,0]
    v_pk_mul_f32 v[148:149], v[146:147], v[136:137] op_sel_hi:[0,1]
    v_cvt_pk_bf16_f32 v97, v164, v165
    v_cvt_pk_bf16_f32 v101, v142, v143
    v_cvt_pk_bf16_f32 v98, v160, v161
    v_pk_mul_f32 v[164:165], v[150:151], v[130:131] op_sel_hi:[0,1]
    v_pk_mul_f32 v[142:143], v[154:155], v[130:131] op_sel_hi:[0,1]
    v_pk_fma_f32 v[144:145], v[162:163], v[124:125], v[144:145] op_sel:[1,1,0] op_sel_hi:[1,0,1] neg_lo:[1,0,0]
    v_pk_mul_f32 v[160:161], v[146:147], v[126:127] op_sel_hi:[0,1]
    v_cvt_pk_bf16_f32 v104, v140, v141
    v_cvt_pk_bf16_f32 v105, v138, v139
    v_pk_fma_f32 v[148:149], v[146:147], v[136:137], v[148:149] op_sel:[1,1,0] op_sel_hi:[1,0,1] neg_lo:[1,0,0]
    v_cvt_pk_bf16_f32 v102, v162, v163
    v_pk_mul_f32 v[138:139], v[156:157], v[122:123] op_sel_hi:[0,1]
    v_pk_mul_f32 v[140:141], v[158:159], v[122:123] op_sel_hi:[0,1]
    v_mov_b32 v12, 0x3f80
    v_cvt_pk_bf16_f32 v13, v132, v133
    v_pk_fma_f32 v[164:165], v[150:151], v[130:131], v[164:165] op_sel:[1,1,0] op_sel_hi:[1,0,1] neg_lo:[1,0,0]
    ds_write_addtid_b32 v12 offset:0
    v_pk_fma_f32 v[142:143], v[154:155], v[130:131], v[142:143] op_sel:[1,1,0] op_sel_hi:[1,0,1] neg_lo:[1,0,0]
    v_cvt_pk_bf16_f32 v103, v144, v145
    ds_write_addtid_b32 v13 offset:4608
    v_cvt_pk_bf16_f32 v108, v146, v147
    v_pk_fma_f32 v[160:161], v[146:147], v[126:127], v[160:161] op_sel:[1,1,0] op_sel_hi:[1,0,1] neg_lo:[1,0,0]
    v_pk_mul_f32 v[162:163], v[152:153], v[126:127] op_sel_hi:[0,1]
    v_pk_mul_f32 v[144:145], v[152:153], v[136:137] op_sel_hi:[0,1]
    v_pk_mul_f32 v[146:147], v[148:149], v[136:137] op_sel_hi:[0,1]
    v_cvt_pk_bf16_f32 v35, v150, v151
    v_cvt_pk_bf16_f32 v121, v154, v155
    v_pk_fma_f32 v[138:139], v[156:157], v[122:123], v[138:139] op_sel:[1,1,0] op_sel_hi:[1,0,1] neg_lo:[1,0,0]
    ds_write_addtid_b32 v35 offset:2016
    v_pk_fma_f32 v[140:141], v[158:159], v[122:123], v[140:141] op_sel:[1,1,0] op_sel_hi:[1,0,1] neg_lo:[1,0,0]
    v_pk_mul_f32 v[150:151], v[164:165], v[130:131] op_sel_hi:[0,1]
    ds_write_addtid_b32 v121 offset:2304
    v_pk_mul_f32 v[154:155], v[142:143], v[130:131] op_sel_hi:[0,1]
    v_pk_fma_f32 v[162:163], v[152:153], v[126:127], v[162:163] op_sel:[1,1,0] op_sel_hi:[1,0,1] neg_lo:[1,0,0]
    v_cvt_pk_bf16_f32 v12, v156, v157
    v_cvt_pk_bf16_f32 v13, v158, v159
    v_pk_fma_f32 v[144:145], v[152:153], v[136:137], v[144:145] op_sel:[1,1,0] op_sel_hi:[1,0,1] neg_lo:[1,0,0]
    ds_write_addtid_b32 v12 offset:5760
    v_pk_fma_f32 v[146:147], v[148:149], v[136:137], v[146:147] op_sel:[1,1,0] op_sel_hi:[1,0,1] neg_lo:[1,0,0]
    v_pk_mul_f32 v[156:157], v[138:139], v[122:123] op_sel_hi:[0,1]
    ds_write_addtid_b32 v13 offset:8064
    v_pk_mul_f32 v[158:159], v[140:141], v[122:123] op_sel_hi:[0,1]
    v_cvt_pk_bf16_f32 v10, v134, v135
    v_pk_fma_f32 v[150:151], v[164:165], v[130:131], v[150:151] op_sel:[1,1,0] op_sel_hi:[1,0,1] neg_lo:[1,0,0]
    v_pk_fma_f32 v[154:155], v[142:143], v[130:131], v[154:155] op_sel:[1,1,0] op_sel_hi:[1,0,1] neg_lo:[1,0,0]
    ds_write_addtid_b32 v10 offset:288
    v_cvt_pk_bf16_f32 v110, v152, v153
    v_cvt_pk_bf16_f32 v111, v162, v163
    v_pk_mul_f32 v[162:163], v[144:145], v[136:137] op_sel_hi:[0,1]
    v_pk_mul_f32 v[152:153], v[146:147], v[136:137] op_sel_hi:[0,1]
    v_cvt_pk_bf16_f32 v4, v130, v131
    v_cvt_pk_bf16_f32 v14, v164, v165
    v_cvt_pk_bf16_f32 v15, v142, v143
    ds_write_addtid_b32 v4 offset:576
    v_pk_fma_f32 v[156:157], v[138:139], v[122:123], v[156:157] op_sel:[1,1,0] op_sel_hi:[1,0,1] neg_lo:[1,0,0]
    v_pk_fma_f32 v[158:159], v[140:141], v[122:123], v[158:159] op_sel:[1,1,0] op_sel_hi:[1,0,1] neg_lo:[1,0,0]
    ds_write_addtid_b32 v14 offset:2592
    v_pk_mul_f32 v[164:165], v[150:151], v[130:131] op_sel_hi:[0,1]
    v_pk_mul_f32 v[142:143], v[154:155], v[130:131] op_sel_hi:[0,1]
    ds_write_addtid_b32 v15 offset:2880
    v_cvt_pk_bf16_f32 v9, v138, v139
    v_cvt_pk_bf16_f32 v10, v140, v141
    v_pk_fma_f32 v[162:163], v[144:145], v[136:137], v[162:163] op_sel:[1,1,0] op_sel_hi:[1,0,1] neg_lo:[1,0,0]
    ds_write_addtid_b32 v9 offset:6048
    v_pk_fma_f32 v[152:153], v[146:147], v[136:137], v[152:153] op_sel:[1,1,0] op_sel_hi:[1,0,1] neg_lo:[1,0,0]
    v_pk_mul_f32 v[138:139], v[156:157], v[122:123] op_sel_hi:[0,1]
    ds_write_addtid_b32 v10 offset:8352
    v_pk_mul_f32 v[140:141], v[158:159], v[122:123] op_sel_hi:[0,1]
    v_cvt_pk_bf16_f32 v4, v150, v151
    v_cvt_pk_bf16_f32 v5, v154, v155
    v_pk_fma_f32 v[164:165], v[150:151], v[130:131], v[164:165] op_sel:[1,1,0] op_sel_hi:[1,0,1] neg_lo:[1,0,0]
    ds_write_addtid_b32 v4 offset:3168
    v_pk_fma_f32 v[142:143], v[154:155], v[130:131], v[142:143] op_sel:[1,1,0] op_sel_hi:[1,0,1] neg_lo:[1,0,0]
    v_pk_mul_f32 v[150:151], v[162:163], v[136:137] op_sel_hi:[0,1]
    ds_write_addtid_b32 v5 offset:3456
    v_pk_mul_f32 v[154:155], v[152:153], v[136:137] op_sel_hi:[0,1]
    v_pk_fma_f32 v[138:139], v[156:157], v[122:123], v[138:139] op_sel:[1,1,0] op_sel_hi:[1,0,1] neg_lo:[1,0,0]
    v_pk_fma_f32 v[140:141], v[158:159], v[122:123], v[140:141] op_sel:[1,1,0] op_sel_hi:[1,0,1] neg_lo:[1,0,0]
    v_cvt_pk_bf16_f32 v109, v160, v161
    v_pk_mul_f32 v[160:161], v[164:165], v[130:131] op_sel_hi:[0,1]
    v_pk_fma_f32 v[150:151], v[162:163], v[136:137], v[150:151] op_sel:[1,1,0] op_sel_hi:[1,0,1] neg_lo:[1,0,0]
    v_pk_fma_f32 v[154:155], v[152:153], v[136:137], v[154:155] op_sel:[1,1,0] op_sel_hi:[1,0,1] neg_lo:[1,0,0]
    v_cvt_pk_bf16_f32 v28, v156, v157
    v_cvt_pk_bf16_f32 v29, v158, v159
    v_cvt_pk_bf16_f32 v32, v138, v139
    ds_write_addtid_b32 v28 offset:6336
    v_cvt_pk_bf16_f32 v33, v140, v141
    v_pk_fma_f32 v[160:161], v[164:165], v[130:131], v[160:161] op_sel:[1,1,0] op_sel_hi:[1,0,1] neg_lo:[1,0,0]
    ds_write_addtid_b32 v29 offset:8640
    v_pk_mul_f32 v[156:157], v[150:151], v[136:137] op_sel_hi:[0,1]
    v_pk_mul_f32 v[138:139], v[154:155], v[136:137] op_sel_hi:[0,1]
    ds_write_addtid_b32 v32 offset:6624
    v_cvt_pk_bf16_f32 v30, v164, v165
    v_cvt_pk_bf16_f32 v31, v142, v143
    ds_write_addtid_b32 v33 offset:8928
    v_cvt_pk_bf16_f32 v34, v160, v161
    v_pk_fma_f32 v[156:157], v[150:151], v[136:137], v[156:157] op_sel:[1,1,0] op_sel_hi:[1,0,1] neg_lo:[1,0,0]
    ds_read_b128 v[64:67], v6 offset:4608
    v_pk_fma_f32 v[138:139], v[154:155], v[136:137], v[138:139] op_sel:[1,1,0] op_sel_hi:[1,0,1] neg_lo:[1,0,0]
    v_cvt_pk_bf16_f32 v112, v148, v149
    ds_read_b128 v[68:71], v6 offset:4672
    v_cvt_pk_bf16_f32 v113, v144, v145
    v_cvt_pk_bf16_f32 v114, v146, v147
    ds_read_b128 v[72:75], v6 offset:4736
    v_cvt_pk_bf16_f32 v115, v162, v163
    v_cvt_pk_bf16_f32 v116, v152, v153
    ds_read_b128 v[76:79], v6 offset:4800
    v_cvt_pk_bf16_f32 v117, v150, v151
    v_cvt_pk_bf16_f32 v118, v154, v155
    ds_write_addtid_b32 v96 offset:4608
    v_cvt_pk_bf16_f32 v119, v156, v157
    v_cvt_pk_bf16_f32 v120, v138, v139
    ds_write_addtid_b32 v97 offset:4896
    ds_write_addtid_b32 v98 offset:5184
    ds_write_addtid_b32 v99 offset:5472
    ds_write_addtid_b32 v100 offset:5760
    ds_write_addtid_b32 v101 offset:6048
    ds_write_addtid_b32 v102 offset:6336
    ds_write_addtid_b32 v103 offset:6624
    ds_write_addtid_b32 v104 offset:6912
    ds_write_addtid_b32 v105 offset:7200
    ds_write_addtid_b32 v106 offset:7488
    ds_write_addtid_b32 v107 offset:7776
    ds_write_addtid_b32 v108 offset:8064
    ds_write_addtid_b32 v109 offset:8352
    ds_write_addtid_b32 v110 offset:8640
    ds_write_addtid_b32 v111 offset:8928
    ds_write_addtid_b32 v30 offset:3744
    ds_write_addtid_b32 v31 offset:4032
    ds_write_addtid_b32 v34 offset:4320
    ds_read_b128 v[80:83], v6 offset:4608
    ds_read_b128 v[84:87], v6 offset:4672
    ds_read_b128 v[88:91], v6 offset:4736
    ds_read_b128 v[92:95], v6 offset:4800
    ds_read_b128 v[48:51], v6 offset:0
    ds_read_b128 v[52:55], v6 offset:64
    ds_read_b128 v[56:59], v6 offset:128
    ds_read_b128 v[60:63], v6 offset:192
    ds_write_addtid_b32 v112 offset:4608
    ds_write_addtid_b32 v113 offset:4896
    ds_write_addtid_b32 v114 offset:5184
    ds_write_addtid_b32 v115 offset:5472
    ds_write_addtid_b32 v116 offset:5760
    ds_write_addtid_b32 v117 offset:6048
    ds_write_addtid_b32 v118 offset:6336
    ds_write_addtid_b32 v119 offset:6624
    ds_write_addtid_b32 v120 offset:6912
    ds_read_b128 v[96:99], v6 offset:4608
    ds_read_b128 v[100:103], v6 offset:4672
    ds_read_b128 v[104:107], v6 offset:4736
    ds_read_b128 v[108:111], v6 offset:4800
    s_waitcnt lgkmcnt(4)
    v_mfma_f32_16x16x32_bf16 v[36:39], v[64:67], v[48:51], 0
    v_mfma_f32_16x16x32_bf16 v[36:39], v[68:71], v[52:55], v[36:39]
    v_mfma_f32_16x16x32_bf16 v[36:39], v[72:75], v[56:59], v[36:39]
    v_mfma_f32_16x16x32_bf16 v[36:39], v[76:79], v[60:63], v[36:39]
    v_mfma_f32_16x16x32_bf16 v[40:43], v[80:83], v[48:51], 0
    v_mfma_f32_16x16x32_bf16 v[40:43], v[84:87], v[52:55], v[40:43]
    v_mfma_f32_16x16x32_bf16 v[40:43], v[88:91], v[56:59], v[40:43]
    v_mfma_f32_16x16x32_bf16 v[40:43], v[92:95], v[60:63], v[40:43]
    s_waitcnt lgkmcnt(0)
    v_mfma_f32_16x16x32_bf16 v[44:47], v[48:51], v[96:99], 0
    v_mfma_f32_16x16x32_bf16 v[44:47], v[52:55], v[100:103], v[44:47]
    v_mfma_f32_16x16x32_bf16 v[44:47], v[56:59], v[104:107], v[44:47]
    v_mfma_f32_16x16x32_bf16 v[44:47], v[60:63], v[108:111], v[44:47]
    s_and_b32 s6, s5, 3
    s_lshl_b32 s6, s6, 2
    v_mov_b32 v4, s6
    v_mov_b32 v5, 1
    v_lshlrev_b32 v9, 4, v1
    s_cmp_ge_u32 s5, 8
    s_cbranch_scc1 L_owner
    v_add_u32 v9, s53, v9
    ds_write_b128 v9, v[36:39] offset:0
    ds_write_b128 v9, v[40:43] offset:1024
    ds_write_b128 v9, v[44:47] offset:2048
    s_mov_b64 exec, 1
    ds_add_u32 v4, v5 offset:20416
    s_mov_b64 exec, -1
    s_sub_u32 s6, s5, 0
    s_cmp_ge_u32 s6, 4
    s_cbranch_scc1 L_pf20
    s_cmp_ge_u32 s50, 16
    s_cbranch_scc1 L_pf20
    s_lshr_b32 s7, s50, 3
    s_cmp_eq_u32 s7, 1
    s_cselect_b64 s[54:55], s[12:13], s[10:11]
    s_mul_i32 s56, s7, 0
    s_and_b32 s7, s6, 1
    s_mul_i32 s7, s7, 655360
    s_add_u32 s56, s56, s7
    s_add_u32 s56, s56, 1310720
    s_bitcmp1_b32 s6, 1
    s_cselect_b32 s7, s52, s51
    s_cbranch_scc0 L_pfg20
    s_cmp_ge_u32 s4, 4
    s_cbranch_scc1 L_pf20
L_pfg20:
    s_add_u32 s56, s56, s7
    v_add_u32 v25, s56, v24
    global_load_dword v26, v25, s[54:55]
L_pf20:
    s_sub_u32 s6, s5, 0
    s_cmp_ge_u32 s6, 4
    s_cbranch_scc1 L_pf21
    s_cmp_ge_u32 s50, 16
    s_cbranch_scc1 L_pf21
    s_lshr_b32 s7, s50, 3
    s_mov_b64 s[54:55], s[8:9]
    s_mul_i32 s56, s7, 1310720
    s_and_b32 s7, s6, 1
    s_mul_i32 s7, s7, 655360
    s_add_u32 s56, s56, s7
    s_add_u32 s56, s56, 0
    s_bitcmp1_b32 s6, 1
    s_cselect_b32 s7, s52, s51
    s_cbranch_scc0 L_pfg21
    s_cmp_ge_u32 s4, 4
    s_cbranch_scc1 L_pf21
L_pfg21:
    s_add_u32 s56, s56, s7
    v_add_u32 v25, s56, v24
    global_load_dword v26, v25, s[54:55]
L_pf21:
    s_cmp_lt_u32 s5, 4
    s_cbranch_scc1 L_helperB
    s_endpgm
L_owner:
    s_nop 1
    s_sub_u32 s6, s5, 8
    s_mul_i32 s6, s6, 9216
    s_add_u32 s6, s6, 81664
    v_add_u32 v9, s6, v9
L_spin22:
    ds_read_b32 v10, v4 offset:20416
    s_waitcnt lgkmcnt(0)
    v_readfirstlane_b32 s7, v10
    s_nop 0
    s_cmp_ge_u32 s7, 2
    s_cbranch_scc1 L_spun22
    s_sleep 1
    s_sub_u32 s57, s57, 1
    s_cbranch_scc0 L_spin22
    s_mov_b32 s57, 0
L_spun22:
    ds_read_b128 v[48:51], v9 offset:0
    ds_read_b128 v[52:55], v9 offset:1024
    ds_read_b128 v[56:59], v9 offset:2048
    ds_read_b128 v[60:63], v9 offset:36864
    ds_read_b128 v[64:67], v9 offset:37888
    ds_read_b128 v[68:71], v9 offset:38912
    v_lshlrev_b32 v3, 4, v1
    v_add_u32 v3, s44, v3
    v_add_u32 v3, 56, v3
    v_mov_b32 v134, 0
    v_mov_b32 v135, 0
    v_lshlrev_b32 v136, 3, v1
    v_add_u32 v136, s44, v136
    v_mov_b32 v137, s44
    ds_write_b64 v136, v[134:135] offset:4160
    ds_write_b64 v136, v[134:135] offset:8800
    ds_write_b64 v136, v[134:135] offset:13480
    ds_write_b32 v137, v134 offset:4156
    ds_write_b32 v137, v134 offset:18492
    v_and_b32 v122, 15, v1
    v_lshrrev_b32 v123, 4, v1
    v_lshrrev_b32 v124, 1, v123
    v_lshlrev_b32 v124, 8, v124
    v_lshl_add_u32 v124, v122, 4, v124
    v_and_b32 v125, 1, v123
    v_lshl_add_u32 v124, v125, 3, v124
    v_add_u32 v124, s44, v124
    v_cmp_gt_u32 vcc, 32, v1
    v_lshlrev_b32 v125, 3, v122
    v_lshlrev_b32 v126, 2, v122
    v_cndmask_b32 v125, v126, v125, vcc
    v_lshl_add_u32 v125, v123, 7, v125
    v_add_u32 v125, s44, v125
    v_mov_b32 v126, 64
    v_cndmask_b32_e64 v126, v126, 4, vcc
    v_add_u32 v126, v125, v126
    v_lshlrev_b32 v127, 5, v122
    v_lshl_add_u32 v127, v123, 3, v127
    v_add_u32 v127, s44, v127
    s_waitcnt vmcnt(0)
    s_mov_b64 exec, 1
    v_add_f32 v36, v36, v23
    s_mov_b64 exec, -1
    s_waitcnt lgkmcnt(5)
    v_pk_add_f32 v[36:37], v[36:37], v[48:49]
    v_pk_add_f32 v[38:39], v[38:39], v[50:51]
    v_pk_add_f32 v[40:41], v[40:41], v[52:53]
    v_pk_add_f32 v[42:43], v[42:43], v[54:55]
    v_pk_add_f32 v[44:45], v[44:45], v[56:57]
    v_pk_add_f32 v[46:47], v[46:47], v[58:59]
    v_pk_add_f32 v[36:37], v[36:37], v[60:61]
    v_pk_add_f32 v[38:39], v[38:39], v[62:63]
    v_pk_add_f32 v[40:41], v[40:41], v[64:65]
    v_pk_add_f32 v[42:43], v[42:43], v[66:67]
    v_pk_add_f32 v[44:45], v[44:45], v[68:69]
    v_pk_add_f32 v[46:47], v[46:47], v[70:71]
    v_cvt_pk_bf16_f32 v128, v36, v37
    v_cvt_pk_bf16_f32 v129, v38, v39
    v_cvt_pk_bf16_f32 v130, v40, v41
    v_cvt_pk_bf16_f32 v131, v42, v43
    v_cvt_pk_bf16_f32 v132, v44, v45
    v_cvt_pk_bf16_f32 v133, v46, v47
    ds_write_b64 v124, v[128:129] offset:18496
    ds_write_b32 v125, v130 offset:19008
    ds_write_b32 v126, v131 offset:19008
    ds_write_b64 v127, v[132:133] offset:19520
    v_lshlrev_b32 v124, 4, v1
    v_lshlrev_b32 v125, 3, v1
    v_add_u32 v125, 256, v125
    v_cndmask_b32 v124, v125, v124, vcc
    v_add_u32 v124, s44, v124
    ds_read_b64 v[48:49], v124 offset:18496
    ds_read_b64 v[50:51], v124 offset:18504
    v_cmp_gt_u32 s[96:97], 33, v1
    v_subrev_u32 v125, 2, v124
    s_nop 0
    v_cndmask_b32_e64 v125, v124, v125, s[96:97]
    ds_read_u16_d16_hi v52, v125 offset:18496
    v_lshlrev_b32 v126, 2, v1
    v_add_u32 v126, s44, v126
    ds_read_b32 v65, v126 offset:19264
    ds_read_u16 v76, v126 offset:19268
    v_lshlrev_b32 v127, 1, v1
    v_add_u32 v127, s44, v127
    ds_read_u16 v77, v127 offset:19520
    ds_read_u16 v78, v127 offset:19522
    ds_read_u16 v79, v127 offset:19648
    ds_read_u16 v80, v127 offset:19650
    v_mov_b32 v72, 0x01000100
    v_mov_b32 v73, 0x03020100
    v_cndmask_b32 v72, v72, v73, vcc
    v_mov_b32 v73, 0x05040302
    v_mov_b32 v60, 0x07060504
    v_cndmask_b32 v73, v73, v60, vcc
    v_mov_b32 v74, 0x01000100
    v_cndmask_b32 v74, v74, v60, vcc
    v_and_b32 v75, 1, v1
    v_cmp_eq_u32 s[96:97], 0, v75
    v_mov_b32 v75, 0x05040504
    v_mov_b32 v60, 0x05040100
    v_cndmask_b32_e64 v75, v75, v60, s[96:97]
    s_mov_b32 s6, 0x01000100
    s_mov_b32 s7, 0x03020302
    s_waitcnt lgkmcnt(0)
    v_perm_b32 v56, v48, v48, v72
    v_perm_b32 v57, v49, v48, v73
    v_perm_b32 v58, v50, v49, v74
    v_alignbit_b32 v59, v50, v49, 16
    v_cndmask_b32 v59, v59, v51, vcc
    v_alignbit_b32 v60, v56, v52, 16
    v_alignbit_b32 v61, v57, v56, 16
    v_alignbit_b32 v62, v58, v57, 16
    v_alignbit_b32 v63, v59, v58, 16
    ds_write_b128 v3, v[56:59] offset:13480
    ds_write_b128 v3, v[60:63] offset:9256
    v_perm_b32 v64, v65, v65, s6
    v_perm_b32 v66, v65, v65, s7
    v_perm_b32 v67, v76, v76, s6
    v_alignbit_b32 v68, v64, v64, 16
    v_alignbit_b32 v69, v65, v64, 16
    v_alignbit_b32 v70, v66, v65, 16
    v_alignbit_b32 v71, v67, v66, 16
    ds_write_b128 v3, v[64:67] offset:14504
    ds_write_b128 v3, v[68:71] offset:10280
    v_perm_b32 v84, v77, v77, s6
    v_perm_b32 v85, v77, v77, s6
    v_perm_b32 v86, v78, v77, v75
    v_perm_b32 v87, v78, v78, s6
    v_alignbit_b32 v88, v84, v84, 16
    v_alignbit_b32 v89, v85, v84, 16
    v_alignbit_b32 v90, v86, v85, 16
    v_alignbit_b32 v91, v87, v86, 16
    ds_write_b128 v3, v[84:87] offset:15528
    ds_write_b128 v3, v[88:91] offset:11304
    v_perm_b32 v92, v79, v79, s6
    v_perm_b32 v93, v79, v79, s6
    v_perm_b32 v94, v80, v79, v75
    v_perm_b32 v95, v80, v80, s6
    v_alignbit_b32 v96, v92, v92, 16
    v_alignbit_b32 v97, v93, v92, 16
    v_alignbit_b32 v98, v94, v93, 16
    v_alignbit_b32 v99, v95, v94, 16
    ds_write_b128 v3, v[92:95] offset:16552
    ds_write_b128 v3, v[96:99] offset:12328
    s_mov_b32 s58, 0
    s_branch L_conv
L_helperB:
    v_mov_b32 v2, v0
    v_mul_u32_u24 v3, 2560, v2
    v_add_u32 v3, s45, v3
    global_load_dwordx2 v[16:17], v3, s[20:21] offset:0
    global_load_dwordx2 v[18:19], v3, s[20:21] offset:1280
    v_add_u32 v3, 655360, v3
    global_load_dwordx2 v[20:21], v3, s[20:21] offset:0
    global_load_dwordx2 v[22:23], v3, s[20:21] offset:1280
    v_add_u32 v3, 655360, v3
    global_load_dwordx2 v[24:25], v3, s[20:21] offset:0
    global_load_dwordx2 v[26:27], v3, s[20:21] offset:1280
    v_add_u32 v3, 655360, v3
    global_load_dwordx2 v[28:29], v3, s[20:21] offset:0
    global_load_dwordx2 v[30:31], v3, s[20:21] offset:1280
    v_lshlrev_b32 v10, 2, v2
    v_sub_u32 v4, 4152, v10
    v_add_u32 v5, 61248, v4
    v_bfe_u32 v10, v1, 2, 2
    v_mul_u32_u24 v12, 20432, v10
    v_lshrrev_b32 v10, 5, v2
    v_lshl_add_u32 v12, v10, 3, v12
    v_bfe_u32 v10, v1, 1, 1
    v_lshl_add_u32 v12, v10, 6, v12
    v_and_b32 v10, 1, v1
    v_lshl_add_u32 v12, v10, 7, v12
    v_bfe_u32 v10, v1, 4, 1
    v_lshl_add_u32 v12, v10, 8, v12
    v_add_u32 v12, 12392, v12
    v_mul_u32_u24 v14, 2560, v2
    s_add_u32 s6, s45, 1280
    v_add_u32 v14, s6, v14
    v_mov_b32 v7, 0
    v_mov_b32 v8, 1
    v_mov_b32 v9, 0
    s_mov_b32 s59, 0x05040100
    s_mov_b32 s60, 0x07060302
    s_waitcnt vmcnt(6)
    v_perm_b32 v32, v16, v18, s59
    ds_write_b32 v4, v32 offset:0
    ds_write_b32 v4, v32 offset:4644
    v_perm_b32 v33, v16, v18, s60
    ds_write_b32 v4, v33 offset:20416
    ds_write_b32 v4, v33 offset:25060
    v_perm_b32 v34, v17, v19, s59
    ds_write_b32 v4, v34 offset:40832
    ds_write_b32 v4, v34 offset:45476
    v_perm_b32 v35, v17, v19, s60
    ds_write_b32 v5, v35 offset:0
    ds_write_b32 v5, v35 offset:4644
    s_mov_b64 exec, 1
    ds_add_u32 v7, v8 offset:0
    s_mov_b64 exec, -1
    v_subrev_u32 v4, 1024, v4
    v_subrev_u32 v5, 1024, v5
    s_waitcnt vmcnt(4)
    v_perm_b32 v36, v20, v22, s59
    ds_write_b32 v4, v36 offset:0
    ds_write_b32 v4, v36 offset:4644
    v_perm_b32 v37, v20, v22, s60
    ds_write_b32 v4, v37 offset:20416
    ds_write_b32 v4, v37 offset:25060
    v_perm_b32 v38, v21, v23, s59
    ds_write_b32 v4, v38 offset:40832
    ds_write_b32 v4, v38 offset:45476
    v_perm_b32 v39, v21, v23, s60
    ds_write_b32 v5, v39 offset:0
    ds_write_b32 v5, v39 offset:4644
    s_mov_b64 exec, 1
    ds_add_u32 v7, v8 offset:4
    s_mov_b64 exec, -1
    v_subrev_u32 v4, 1024, v4
    v_subrev_u32 v5, 1024, v5
    s_waitcnt vmcnt(2)
    v_perm_b32 v32, v24, v26, s59
    ds_write_b32 v4, v32 offset:0
    ds_write_b32 v4, v32 offset:4644
    v_perm_b32 v33, v24, v26, s60
    ds_write_b32 v4, v33 offset:20416
    ds_write_b32 v4, v33 offset:25060
    v_perm_b32 v34, v25, v27, s59
    ds_write_b32 v4, v34 offset:40832
    ds_write_b32 v4, v34 offset:45476
    v_perm_b32 v35, v25, v27, s60
    ds_write_b32 v5, v35 offset:0
    ds_write_b32 v5, v35 offset:4644
    s_mov_b64 exec, 1
    ds_add_u32 v7, v8 offset:8
    s_mov_b64 exec, -1
    v_subrev_u32 v4, 1024, v4
    v_subrev_u32 v5, 1024, v5
    s_waitcnt vmcnt(0)
    v_perm_b32 v36, v28, v30, s59
    ds_write_b32 v4, v36 offset:0
    ds_write_b32 v4, v36 offset:4644
    v_perm_b32 v37, v28, v30, s60
    ds_write_b32 v4, v37 offset:20416
    ds_write_b32 v4, v37 offset:25060
    v_perm_b32 v38, v29, v31, s59
    ds_write_b32 v4, v38 offset:40832
    ds_write_b32 v4, v38 offset:45476
    v_perm_b32 v39, v29, v31, s60
    ds_write_b32 v5, v39 offset:0
    ds_write_b32 v5, v39 offset:4644
    s_mov_b64 exec, 1
    ds_add_u32 v7, v8 offset:12
    s_mov_b64 exec, -1
    s_mov_b32 s47, 0
    s_nop 0
L_hBloop:
L_spin23:
    ds_read_b32 v10, v7 offset:16
    s_waitcnt lgkmcnt(0)
    v_readfirstlane_b32 s7, v10
    s_nop 0
    s_cmp_ge_u32 s7, 4
    s_cbranch_scc1 L_spun23
    s_sleep 1
    s_sub_u32 s57, s57, 1
    s_cbranch_scc0 L_spin23
    s_mov_b32 s57, 0
L_spun23:
    ds_read_b64_tr_b16 v[40:41], v12 offset:0
    s_waitcnt lgkmcnt(0)
    global_store_dwordx2 v14, v[40:41], s[38:39]
    v_add_u32 v14, 655360, v14
L_spin24:
    ds_read_b32 v10, v7 offset:20
    s_waitcnt lgkmcnt(0)
    v_readfirstlane_b32 s7, v10
    s_nop 0
    s_cmp_ge_u32 s7, 4
    s_cbranch_scc1 L_spun24
    s_sleep 1
    s_sub_u32 s57, s57, 1
    s_cbranch_scc0 L_spin24
    s_mov_b32 s57, 0
L_spun24:
    ds_read_b64_tr_b16 v[42:43], v12 offset:4224
    s_waitcnt lgkmcnt(0)
    global_store_dwordx2 v14, v[42:43], s[38:39]
    v_add_u32 v14, 655360, v14
    v_subrev_u32 v12, 1024, v12
    v_add_u32 v7, 8, v7
    s_add_u32 s47, s47, 1
    s_cmp_lt_u32 s47, 4
    s_cbranch_scc1 L_hBloop
L_end:
    s_endpgm
.section .rodata,"a"
.p2align 6
.amdhsa_kernel concat_heads__ssm_conv_h3__ssm_conv_s4__prompt_kernel
  .amdhsa_next_free_vgpr 168
  .amdhsa_next_free_sgpr 102
  .amdhsa_accum_offset 168
  .amdhsa_group_segment_fixed_size 0
  .amdhsa_kernarg_size 144
  .amdhsa_user_sgpr_count 2
  .amdhsa_user_sgpr_kernarg_segment_ptr 1
  .amdhsa_system_sgpr_workgroup_id_x 1
.end_amdhsa_kernel
```
